```python
import torch

def _softmax(x, axis=-1):
    return torch.softmax(x, dim=axis)

def _gelu(x):
    return torch.nn.functional.gelu(x, approximate='tanh')

def _silu(x):
    return torch.nn.functional.silu(x)

def _sigmoid(x):
    return torch.sigmoid(x)

def _layernorm(x, axis=-1, eps=1e-05):
    m = x.mean(dim=axis, keepdim=True)
    v = x.var(dim=axis, keepdim=True, unbiased=False)
    return (x - m) / torch.sqrt(v + eps)

def _scatter_add(tgt, idx, src, axis=0):
    return tgt.clone().index_add_(axis, idx, src)

def _segment_sum(src, seg, n):
    out = torch.zeros((n,) + src.shape[1:], dtype=src.dtype)
    return out.index_add_(0, seg, src)

def _pad(x, pw):
    flat = tuple((v for pair in reversed(pw) for v in pair))
    return torch.nn.functional.pad(x, flat)
kernel_name = 'adaLN_cond__gqa_block_cached__mixer_channel_mlp__decode'

def setup_inputs():

    _w = lambda a: (lambda t: t.to(torch.bfloat16) if t.is_floating_point() else t)(torch.as_tensor(a))

    def _A_setup():
        B, Sq, D = (2, 1, 1024)
        Hq, Hkv, Sk, Dh = (32, 4, 32768, 128)
        assert Hq % Hkv == 0, (Hq, Hkv)
        return {'x': _w((lambda *s: torch.randn(*s, dtype=torch.bfloat16) * 0.1)(B, Sq, D)), 'k_cache': _w((lambda *s: torch.randn(*s, dtype=torch.bfloat16) * 1.6)(B, Hkv, Sk, Dh)), 'v_cache': _w((lambda *s: torch.randn(*s, dtype=torch.bfloat16) * 0.8)(B, Hkv, Sk, Dh)), 'wq': _w((lambda *s: torch.randn(*s, dtype=torch.bfloat16) * 1.6)(D, Hq * Dh) * D ** (-0.5)), 'wo': _w((lambda *s: torch.randn(*s, dtype=torch.bfloat16) * 0.8)(Hq * Dh, D) * (Hq * Dh) ** (-0.5))}
    _A_in = _A_setup()

    def _B_setup():
        B, S, D, F = (2, 1, 1024, 3584)
        return {'x': _w((lambda *s: torch.randn(*s, dtype=torch.bfloat16) * 0.1)(B, S, D)), 'w1': _w((lambda *s: torch.randn(*s, dtype=torch.bfloat16) * 3.2)(D, F) * D ** (-0.5)), 'b1': _w((lambda *s: torch.randn(*s, dtype=torch.bfloat16) * 3.2)(F)), 'w2': _w((lambda *s: torch.randn(*s, dtype=torch.bfloat16) * 3.2)(F, D) * F ** (-0.5)), 'b2': _w((lambda *s: torch.randn(*s, dtype=torch.bfloat16) * 3.2)(D))}
    _B_in = _B_setup()
    return {'A_x': _A_in['x'], 'A_k_cache': _A_in['k_cache'], 'A_v_cache': _A_in['v_cache'], 'A_wq': _A_in['wq'], 'A_wo': _A_in['wo'], 'B_x': _B_in['x'], 'B_w1': _B_in['w1'], 'B_b1': _B_in['b1'], 'B_w2': _B_in['w2'], 'B_b2': _B_in['b2'], 'c': _w((lambda *s: torch.randn(*s, dtype=torch.bfloat16) * 0.2)(2, 1024) * 8.0), 'w_mod': _w((lambda *s: torch.randn(*s, dtype=torch.bfloat16) * 0.2)(1024, 6 * 1024) * 1024 ** (-0.5) * 8.0)}

def reference(A_x, A_k_cache, A_v_cache, A_wq, A_wo, B_x, B_w1, B_b1, B_w2, B_b2, c, w_mod):

    def _A_ref(x, k_cache, v_cache, wq, wo):
        B, Sq, D = x.shape
        Hq, Dh = (32, 128)
        Hkv = k_cache.shape[1]
        rep = Hq // Hkv
        q = (lambda x, *d: x.permute(*d))((x @ wq).reshape(B, Sq, Hq, Dh), 0, 2, 1, 3)
        k = (lambda x, n, axis: torch.repeat_interleave(x, n, dim=axis))(k_cache, rep, axis=1)
        v = (lambda x, n, axis: torch.repeat_interleave(x, n, dim=axis))(v_cache, rep, axis=1)
        scores = torch.einsum('bhqd,bhkd->bhqk', q, k) * Dh ** (-0.5)
        p = _softmax(scores, axis=-1)
        o = torch.einsum('bhqk,bhkd->bhqd', p, v)
        return (lambda x, *d: x.permute(*d))(o, 0, 2, 1, 3).reshape(B, Sq, Hq * Dh) @ wo

    def _B_ref(x, w1, b1, w2, b2):
        y = _layernorm(x, axis=-1)
        h = _gelu(torch.einsum('bsd,df->bsf', y, w1) + b1)
        return torch.einsum('bsf,fd->bsd', h, w2) + b2
    x = A_x
    mod = (_silu(c) @ w_mod).reshape(c.shape[0], 6, 1, -1)
    sa, ca, ga, sb, cb, gb = (mod[:, 0].clone(), mod[:, 1].clone(), mod[:, 2].clone(), mod[:, 3].clone(), mod[:, 4].clone(), mod[:, 5].clone())
    h = _layernorm(x, axis=-1) * (1 + ca) + sa
    x = x + ga * _A_ref(h, A_k_cache, A_v_cache, A_wq, A_wo)
    h = _layernorm(x, axis=-1) * (1 + cb) + sb
    x = x + gb * _B_ref(h, B_w1, B_b1, B_w2, B_b2)
    return x
```

```asm
; @launch grid=(256,1,1) block=(512,1,1) lds=135168
.amdgcn_target "amdgcn-amd-amdhsa--gfx950"
.text
.globl adaLN_cond__gqa_block_cached__mixer_channel_mlp__decode_kernel
.p2align 8
.type adaLN_cond__gqa_block_cached__mixer_channel_mlp__decode_kernel,@function
adaLN_cond__gqa_block_cached__mixer_channel_mlp__decode_kernel:
    s_load_dwordx16 s[16:31], s[0:1], 0
    s_load_dwordx8 s[32:39], s[0:1], 64
    s_load_dwordx4 s[40:43], s[0:1], 96
    s_load_dwordx2 s[44:45], s[0:1], 112
    v_lshrrev_b32 v1, 6, v0
    v_and_b32 v0, 63, v0
    v_readfirstlane_b32 s3, v1
    s_cmp_lt_u32 s2, 64
    s_cbranch_scc1 L_proj
    s_cmp_ge_u32 s2, 256
    s_cbranch_scc1 L_exit
L_attn:
    s_sub_u32 s69, s2, 64
    s_mul_hi_u32 s47, s69, 178956971
    s_mul_i32 s68, s47, 23
    s_sub_u32 s68, s69, s68
    s_sub_u32 s69, s68, 24
    s_cselect_b32 s68, s68, s69
    s_lshl_b32 s98, s68, 3
    s_add_u32 s98, s98, s3
    s_mul_i32 s96, s47, 64
    s_add_u32 s4, s96, s98
    s_and_b32 s4, s4, 1023
    s_lshl_b32 s4, s4, 13
    s_add_u32 s5, s4, 4096
    v_bfe_u32 v1, v0, 1, 1
    v_lshlrev_b32 v1, 10, v1
    v_bfe_u32 v8, v0, 2, 2
    v_lshl_add_u32 v1, v8, 8, v1
    v_and_b32 v8, 1, v0
    v_lshl_add_u32 v1, v8, 6, v1
    v_bfe_u32 v8, v0, 4, 2
    v_lshl_add_u32 v1, v8, 4, v1
    s_lshl_b32 s99, s47, 23
    s_mov_b32 s58, 0x800000
    s_mov_b32 s59, 0x20000
    s_waitcnt lgkmcnt(0)
    s_add_u32 s56, s18, s99
    s_addc_u32 s57, s19, 0
    buffer_load_dwordx4 v[64:67], v1, s[56:59], s4 offen offset:0 nt
    buffer_load_dwordx4 v[68:71], v1, s[56:59], s4 offen offset:128 nt
    buffer_load_dwordx4 v[72:75], v1, s[56:59], s4 offen offset:2048 nt
    buffer_load_dwordx4 v[76:79], v1, s[56:59], s4 offen offset:2176 nt
    s_mov_b32 s64, 0x05040100
    s_mov_b32 s65, 0x07060302
    s_mov_b32 s66, 0xffff0000
    s_add_u32 s60, s20, s99
    s_addc_u32 s61, s21, 0
    s_mov_b32 s62, 0x800000
    s_mov_b32 s63, 0x20000
    s_mul_i32 s69, s3, 17
    s_add_u32 s69, s69, s68
    s_cmp_lt_u32 s68, 17
    s_cselect_b32 s69, s69, 1023
    s_add_u32 s6, s96, s98
    s_add_u32 s6, s6, 192
    s_and_b32 s6, s6, 1023
    s_lshl_b32 s6, s6, 13
    s_add_u32 s7, s6, 4096
    s_add_u32 s8, s96, s98
    s_add_u32 s8, s8, 384
    s_and_b32 s8, s8, 1023
    s_lshl_b32 s8, s8, 13
    s_add_u32 s9, s8, 4096
    s_add_u32 s10, s96, s98
    s_add_u32 s10, s10, 576
    s_and_b32 s10, s10, 1023
    s_lshl_b32 s10, s10, 13
    s_add_u32 s11, s10, 4096
    s_add_u32 s12, s96, s98
    s_add_u32 s12, s12, 768
    s_and_b32 s12, s12, 1023
    s_lshl_b32 s12, s12, 13
    s_add_u32 s13, s12, 4096
    s_add_u32 s14, s96, s69
    s_add_u32 s14, s14, 904
    s_and_b32 s14, s14, 1023
    s_lshl_b32 s14, s14, 13
    s_add_u32 s15, s14, 4096
    s_add_u32 s99, s96, s69
    s_add_u32 s99, s99, 608
    s_and_b32 s99, s99, 1023
    s_lshl_b32 s99, s99, 13
    s_cmp_ge_u32 s69, 108
    s_cselect_b32 s14, s99, s14
    s_add_u32 s15, s14, 4096
    s_sub_u32 s99, s98, 140
    s_cmp_lt_u32 s99, 4
    s_cselect_b32 s0, 0xff800000, 0
    v_lshlrev_b32 v2, 4, v0
    s_cmp_lt_u32 s69, 112
    s_cselect_b32 s98, 0, 0x1000000
    s_cselect_b32 s100, 0, 0xff800000
    v_add_u32 v7, s98, v1
    s_cmp_le_u32 s68, 17
    s_cbranch_scc1 L_noex_1
    s_cmp_ge_u32 s3, 2
    s_cbranch_scc1 L_noex_1
    s_mul_i32 s12, s3, 6
    s_add_u32 s12, s12, s68
    s_add_u32 s12, s12, s96
    s_add_u32 s12, s12, 994
    s_and_b32 s12, s12, 1023
    s_lshl_b32 s12, s12, 13
    s_add_u32 s13, s12, 4096
    s_mov_b32 s69, 0
L_noex_1:
    s_cmp_lt_u32 s69, 136
    s_cselect_b32 s101, 0, 0x1000000
    s_cselect_b32 s46, 0, 0xff800000
    v_add_u32 v6, s101, v1
    s_lshr_b32 s43, s0, 7
    s_cmp_lt_u32 s68, 17
    s_cbranch_scc1 L_noev_2
    s_mov_b32 s14, s12
    s_lshr_b32 s69, s46, 7
    s_add_u32 s15, s14, 4096
    v_add_u32 v7, s69, v2
L_noev_2:
    s_mov_b32 s48, s44
    s_mov_b32 s49, s45
    s_mov_b32 s50, 0x400000
    s_mov_b32 s51, 0x20000
    v_bfe_u32 v62, v0, 5, 1
    v_lshlrev_b32 v62, 14, v62
    v_and_b32 v56, 31, v0
    v_lshl_add_u32 v62, v56, 3, v62
    s_and_b32 s69, s47, 3
    s_lshl_b32 s69, s69, 3
    s_add_u32 s69, s69, s3
    s_mul_i32 s69, s69, 32768
    s_lshr_b32 s96, s47, 2
    s_mul_i32 s96, s96, 32
    s_add_u32 s96, s96, s68
    s_lshl_b32 s96, s96, 8
    s_add_u32 s96, s96, s69
    s_add_u32 s96, s96, 1048576
    buffer_load_dword v58, off, s[48:51], 0 sc1
    s_and_b32 s101, s47, 3
    s_lshl_b32 s101, s101, 2
    v_and_b32 v3, 7, v0
    v_lshlrev_b32 v3, 8, v3
    v_bfe_u32 v8, v0, 3, 1
    v_lshl_add_u32 v3, v8, 6, v3
    v_bfe_u32 v8, v0, 4, 2
    v_lshl_add_u32 v3, v8, 4, v3
    v_and_b32 v63, 15, v0
    v_lshlrev_b32 v63, 6, v63
    s_lshl_b32 s69, s3, 3
    v_add_u32 v8, s69, v63
    v_mov_b32 v9, -1
    ds_write_b32 v8, v9 offset:4
    v_mov_b32 v56, 0
    ds_write_b32 v56, v56 offset:3072
    s_mov_b32 s97, 0
    s_waitcnt lgkmcnt(0)
    s_barrier
    v_mov_b32 v4, 0x3db504f3
    v_mov_b32 v5, 0xff800000
L_attn_body:
    buffer_load_dwordx4 v[80:83], v1, s[56:59], s5 offen offset:0 nt
    buffer_load_dwordx4 v[84:87], v1, s[56:59], s5 offen offset:128 nt
    buffer_load_dwordx4 v[88:91], v1, s[56:59], s5 offen offset:2048 nt
    buffer_load_dwordx4 v[92:95], v1, s[56:59], s5 offen offset:2176 nt
    s_waitcnt vmcnt(8)
    buffer_load_dwordx4 v[96:99], v1, s[56:59], s6 offen offset:0 nt
    s_waitcnt vmcnt(8)
    buffer_load_dwordx4 v[100:103], v1, s[56:59], s6 offen offset:128 nt
    s_waitcnt vmcnt(8)
    buffer_load_dwordx4 v[104:107], v1, s[56:59], s6 offen offset:2048 nt
    s_waitcnt vmcnt(8)
    buffer_load_dwordx4 v[108:111], v1, s[56:59], s6 offen offset:2176 nt
    s_waitcnt vmcnt(7)
    buffer_load_dwordx4 v[112:115], v1, s[56:59], s7 offen offset:0 nt
    s_waitcnt vmcnt(7)
    buffer_load_dwordx4 v[116:119], v1, s[56:59], s7 offen offset:128 nt
    s_waitcnt vmcnt(7)
    buffer_load_dwordx4 v[120:123], v1, s[56:59], s7 offen offset:2048 nt
    s_waitcnt vmcnt(7)
    buffer_load_dwordx4 v[124:127], v1, s[56:59], s7 offen offset:2176 nt
    s_waitcnt vmcnt(7)
    buffer_load_dwordx4 v[128:131], v1, s[56:59], s8 offen offset:0 nt
    s_waitcnt vmcnt(7)
    buffer_load_dwordx4 v[132:135], v1, s[56:59], s8 offen offset:128 nt
    s_waitcnt vmcnt(7)
    buffer_load_dwordx4 v[136:139], v1, s[56:59], s8 offen offset:2048 nt
    s_waitcnt vmcnt(7)
    buffer_load_dwordx4 v[140:143], v1, s[56:59], s8 offen offset:2176 nt
    s_waitcnt vmcnt(7)
    buffer_load_dwordx4 v[144:147], v1, s[56:59], s9 offen offset:0 nt
    v_readfirstlane_b32 s27, v58
    s_mul_i32 s26, s27, 0x9e3779b1
    s_lshr_b32 s26, s26, 12
    s_or_b32 s26, s26, 1
    s_add_u32 s27, s27, s26
    s_and_b32 s26, s27, 255
    s_and_b32 s1, s27, 0xffff
    s_waitcnt vmcnt(7)
    buffer_load_dwordx4 v[148:151], v1, s[56:59], s9 offen offset:128 nt
    s_waitcnt vmcnt(7)
    buffer_load_dwordx4 v[152:155], v1, s[56:59], s9 offen offset:2048 nt
    s_waitcnt vmcnt(7)
    buffer_load_dwordx4 v[156:159], v1, s[56:59], s9 offen offset:2176 nt
    s_waitcnt vmcnt(7)
    s_lshr_b32 s69, s0, 7
    v_add_u32 v59, s69, v1
    buffer_load_dwordx4 v[160:163], v59, s[56:59], s10 offen offset:0 nt
    s_waitcnt vmcnt(7)
    buffer_load_dwordx4 v[164:167], v59, s[56:59], s10 offen offset:128 nt
    s_waitcnt vmcnt(7)
    buffer_load_dwordx4 v[168:171], v59, s[56:59], s10 offen offset:2048 nt
    s_waitcnt vmcnt(7)
    buffer_load_dwordx4 v[172:175], v59, s[56:59], s10 offen offset:2176 nt
    s_waitcnt vmcnt(7)
    buffer_load_dwordx4 v[176:179], v59, s[56:59], s11 offen offset:0 nt
    s_waitcnt vmcnt(7)
    buffer_load_dwordx4 v[180:183], v59, s[56:59], s11 offen offset:128 nt
    s_waitcnt vmcnt(7)
    buffer_load_dwordx4 v[184:187], v59, s[56:59], s11 offen offset:2048 nt
    s_waitcnt vmcnt(7)
    buffer_load_dwordx4 v[188:191], v59, s[56:59], s11 offen offset:2176 nt
    s_waitcnt vmcnt(7)
    buffer_load_dwordx4 v[192:195], v6, s[56:59], s12 offen offset:0 nt
    s_waitcnt vmcnt(7)
    buffer_load_dwordx4 v[196:199], v6, s[56:59], s12 offen offset:128 nt
    s_waitcnt vmcnt(7)
    buffer_load_dwordx4 v[200:203], v6, s[56:59], s12 offen offset:2048 nt
    s_waitcnt vmcnt(7)
    buffer_load_dwordx4 v[204:207], v6, s[56:59], s12 offen offset:2176 nt
    s_waitcnt vmcnt(7)
    buffer_load_dwordx4 v[208:211], v6, s[56:59], s13 offen offset:0 nt
    s_waitcnt vmcnt(7)
    buffer_load_dwordx4 v[212:215], v6, s[56:59], s13 offen offset:128 nt
    s_waitcnt vmcnt(7)
    buffer_load_dwordx4 v[216:219], v6, s[56:59], s13 offen offset:2048 nt
    s_waitcnt vmcnt(7)
    buffer_load_dwordx4 v[220:223], v6, s[56:59], s13 offen offset:2176 nt
    s_cmp_lg_u32 s3, 7
    s_cbranch_scc1 L_skip_3
    s_cmp_eq_u32 s97, 2
    s_cbranch_scc1 L_skip_3
    s_cmp_eq_u32 s97, 0
    s_cbranch_scc1 L_q1_4
    v_bitop3_b32 v56, v40, v41, s27 bitop3:0x7e
    v_bitop3_b32 v56, v56, v42, s27 bitop3:0xf6
    v_bitop3_b32 v56, v56, v43, s27 bitop3:0xf6
    v_bitop3_b32 v56, v56, v44, s27 bitop3:0xf6
    v_bitop3_b32 v56, v56, v45, s27 bitop3:0xf6
    v_bitop3_b32 v56, v56, v46, s27 bitop3:0xf6
    v_bitop3_b32 v56, v56, v47, s27 bitop3:0xf6
    v_bitop3_b32 v56, v56, v48, s27 bitop3:0xf6
    v_bitop3_b32 v56, v56, v49, s27 bitop3:0xf6
    v_bitop3_b32 v56, v56, v50, s27 bitop3:0xf6
    v_bitop3_b32 v56, v56, v51, s27 bitop3:0xf6
    v_bitop3_b32 v56, v56, v52, s27 bitop3:0xf6
    v_bitop3_b32 v56, v56, v53, s27 bitop3:0xf6
    v_bitop3_b32 v56, v56, v54, s27 bitop3:0xf6
    v_bitop3_b32 v56, v56, v55, s27 bitop3:0xf6
    v_cmp_ne_u16 vcc, 0, v56
    s_cbranch_vccz L_q3_5
L_q1_4:
    s_lshl_b32 s69, s47, 12
    s_add_u32 s69, s69, 32768
    s_mov_b32 s97, 1
    buffer_load_dwordx4 v[40:43], v2, s[48:51], s69 offen offset:0 sc1
    buffer_load_dwordx4 v[44:47], v2, s[48:51], s69 offen offset:1024 sc1
    buffer_load_dwordx4 v[48:51], v2, s[48:51], s69 offen offset:2048 sc1
    buffer_load_dwordx4 v[52:55], v2, s[48:51], s69 offen offset:3072 sc1
    s_branch L_skip_3
L_q3_5:
    v_lshlrev_b32 v56, 3, v0
    v_perm_b32 v8, v41, v40, s65
    v_perm_b32 v9, v43, v42, s65
    v_perm_b32 v10, v45, v44, s65
    v_perm_b32 v11, v47, v46, s65
    v_perm_b32 v12, v49, v48, s65
    v_perm_b32 v13, v51, v50, s65
    v_perm_b32 v14, v53, v52, s65
    v_perm_b32 v15, v55, v54, s65
    ds_write_b64 v56, v[8:9] offset:1024
    ds_write_b64 v56, v[10:11] offset:1536
    ds_write_b64 v56, v[12:13] offset:2048
    ds_write_b64 v56, v[14:15] offset:2560
    v_mov_b32 v56, 0
    v_mov_b32 v57, 1
    s_mov_b32 s97, 2
    s_waitcnt lgkmcnt(0)
    ds_write_b32 v56, v57 offset:3072
L_skip_3:
    s_waitcnt vmcnt(7)
    s_cmp_lt_u32 s68, 17
    s_cbranch_scc1 L_k5_7
    buffer_load_dwordx4 v[224:227], v7, s[60:63], s14 offen offset:0 nt
    s_branch L_k5j_8
L_k5_7:
    buffer_load_dwordx4 v[224:227], v7, s[56:59], s14 offen offset:0 nt
L_k5j_8:
    s_waitcnt vmcnt(7)
    s_cmp_lt_u32 s68, 17
    s_cbranch_scc1 L_k5_9
    buffer_load_dwordx4 v[228:231], v7, s[60:63], s14 offen offset:1024 nt
    s_branch L_k5j_10
L_k5_9:
    buffer_load_dwordx4 v[228:231], v7, s[56:59], s14 offen offset:128 nt
L_k5j_10:
    s_waitcnt vmcnt(7)
    s_cmp_lt_u32 s68, 17
    s_cbranch_scc1 L_k5_11
    buffer_load_dwordx4 v[232:235], v7, s[60:63], s14 offen offset:2048 nt
    s_branch L_k5j_12
L_k5_11:
    buffer_load_dwordx4 v[232:235], v7, s[56:59], s14 offen offset:2048 nt
L_k5j_12:
    s_waitcnt vmcnt(7)
    s_cmp_lt_u32 s68, 17
    s_cbranch_scc1 L_k5_13
    buffer_load_dwordx4 v[236:239], v7, s[60:63], s14 offen offset:3072 nt
    s_branch L_k5j_14
L_k5_13:
    buffer_load_dwordx4 v[236:239], v7, s[56:59], s14 offen offset:2176 nt
L_k5j_14:
    s_waitcnt vmcnt(7)
    s_cmp_lt_u32 s68, 17
    s_cbranch_scc1 L_k5_15
    buffer_load_dwordx4 v[240:243], v7, s[60:63], s15 offen offset:0 nt
    s_branch L_k5j_16
L_k5_15:
    buffer_load_dwordx4 v[240:243], v7, s[56:59], s15 offen offset:0 nt
L_k5j_16:
    s_waitcnt vmcnt(7)
    s_cmp_lt_u32 s68, 17
    s_cbranch_scc1 L_k5_17
    buffer_load_dwordx4 v[244:247], v7, s[60:63], s15 offen offset:1024 nt
    s_branch L_k5j_18
L_k5_17:
    buffer_load_dwordx4 v[244:247], v7, s[56:59], s15 offen offset:128 nt
L_k5j_18:
    s_waitcnt vmcnt(7)
    s_cmp_lt_u32 s68, 17
    s_cbranch_scc1 L_k5_19
    buffer_load_dwordx4 v[248:251], v7, s[60:63], s15 offen offset:2048 nt
    s_branch L_k5j_20
L_k5_19:
    buffer_load_dwordx4 v[248:251], v7, s[56:59], s15 offen offset:2048 nt
L_k5j_20:
    s_waitcnt vmcnt(7)
    s_cmp_lt_u32 s68, 17
    s_cbranch_scc1 L_k5_21
    buffer_load_dwordx4 v[252:255], v7, s[60:63], s15 offen offset:3072 nt
    s_branch L_k5j_22
L_k5_21:
    buffer_load_dwordx4 v[252:255], v7, s[56:59], s15 offen offset:2176 nt
L_k5j_22:
    s_waitcnt vmcnt(7)
    s_cmp_lg_u32 s3, 7
    s_cbranch_scc1 L_skip_23
    s_cmp_eq_u32 s97, 2
    s_cbranch_scc1 L_skip_23
    s_cmp_eq_u32 s97, 0
    s_cbranch_scc1 L_q1_24
    v_bitop3_b32 v56, v40, v41, s27 bitop3:0x7e
    v_bitop3_b32 v56, v56, v42, s27 bitop3:0xf6
    v_bitop3_b32 v56, v56, v43, s27 bitop3:0xf6
    v_bitop3_b32 v56, v56, v44, s27 bitop3:0xf6
    v_bitop3_b32 v56, v56, v45, s27 bitop3:0xf6
    v_bitop3_b32 v56, v56, v46, s27 bitop3:0xf6
    v_bitop3_b32 v56, v56, v47, s27 bitop3:0xf6
    v_bitop3_b32 v56, v56, v48, s27 bitop3:0xf6
    v_bitop3_b32 v56, v56, v49, s27 bitop3:0xf6
    v_bitop3_b32 v56, v56, v50, s27 bitop3:0xf6
    v_bitop3_b32 v56, v56, v51, s27 bitop3:0xf6
    v_bitop3_b32 v56, v56, v52, s27 bitop3:0xf6
    v_bitop3_b32 v56, v56, v53, s27 bitop3:0xf6
    v_bitop3_b32 v56, v56, v54, s27 bitop3:0xf6
    v_bitop3_b32 v56, v56, v55, s27 bitop3:0xf6
    v_cmp_ne_u16 vcc, 0, v56
    s_cbranch_vccz L_q3_25
L_q1_24:
    s_lshl_b32 s69, s47, 12
    s_add_u32 s69, s69, 32768
    s_mov_b32 s97, 1
    buffer_load_dwordx4 v[40:43], v2, s[48:51], s69 offen offset:0 sc1
    buffer_load_dwordx4 v[44:47], v2, s[48:51], s69 offen offset:1024 sc1
    buffer_load_dwordx4 v[48:51], v2, s[48:51], s69 offen offset:2048 sc1
    buffer_load_dwordx4 v[52:55], v2, s[48:51], s69 offen offset:3072 sc1
    s_branch L_skip_23
L_q3_25:
    v_lshlrev_b32 v56, 3, v0
    v_perm_b32 v8, v41, v40, s65
    v_perm_b32 v9, v43, v42, s65
    v_perm_b32 v10, v45, v44, s65
    v_perm_b32 v11, v47, v46, s65
    v_perm_b32 v12, v49, v48, s65
    v_perm_b32 v13, v51, v50, s65
    v_perm_b32 v14, v53, v52, s65
    v_perm_b32 v15, v55, v54, s65
    ds_write_b64 v56, v[8:9] offset:1024
    ds_write_b64 v56, v[10:11] offset:1536
    ds_write_b64 v56, v[12:13] offset:2048
    ds_write_b64 v56, v[14:15] offset:2560
    v_mov_b32 v56, 0
    v_mov_b32 v57, 1
    s_mov_b32 s97, 2
    s_waitcnt lgkmcnt(0)
    ds_write_b32 v56, v57 offset:3072
L_skip_23:
    s_lshl_b32 s98, s3, 14
    s_add_u32 m0, s98, 4096
    s_mov_b32 s95, 0x20000
    s_cmp_lt_u32 s68, 17
    s_cbranch_scc1 L_xv_27
    s_lshl_b32 s69, s3, 6
    v_add_u32 v57, s69, v0
    v_bfe_u32 v6, v57, 3, 6
    v_mul_u32_u24 v6, 57344, v6
    v_and_b32 v58, 7, v57
    v_lshl_add_u32 v6, v58, 4, v6
    v_mov_b32 v7, v6
    s_mul_i32 s69, s47, 6
    s_add_u32 s69, s69, s68
    s_sub_u32 s69, s69, 14
    s_mul_hi_u32 s98, s69, 613566757
    s_add_u32 s69, s69, s98
    s_sub_u32 s69, s69, 4
    s_lshl_b32 s98, s47, 3
    s_add_u32 s98, s98, 3
    s_min_u32 s98, s98, 55
    s_cmp_eq_u32 s68, 17
    s_cselect_b32 s69, s98, s69
    s_lshl_b32 s12, s69, 7
    s_add_u32 s14, s12, 3670016
    s_mov_b32 s13, 7168
    s_mov_b32 s92, s28
    s_mov_b32 s93, s29
    s_mov_b32 s94, 7340032
    s_branch L_xj_28
L_xv_27:
    v_sub_u32 v57, v2, v1
    v_add_u32 v6, v6, v57
    v_add_u32 v7, v7, v57
    s_mov_b32 s13, 1024
    s_mov_b32 s92, s60
    s_mov_b32 s93, s61
    s_mov_b32 s94, s62
L_xj_28:
    s_nop 0
    buffer_load_dwordx4 v6, s[92:95], s12 offen nt lds
    s_waitcnt vmcnt(7)
    s_add_u32 m0, m0, 1024
    s_add_u32 s12, s12, s13
    buffer_load_dwordx4 v6, s[92:95], s12 offen nt lds
    s_waitcnt vmcnt(7)
    s_add_u32 m0, m0, 1024
    s_add_u32 s12, s12, s13
    buffer_load_dwordx4 v6, s[92:95], s12 offen nt lds
    s_waitcnt vmcnt(7)
    s_add_u32 m0, m0, 1024
    s_add_u32 s12, s12, s13
    buffer_load_dwordx4 v6, s[92:95], s12 offen nt lds
    s_waitcnt vmcnt(7)
    s_add_u32 m0, m0, 1024
    s_add_u32 s12, s12, s13
    buffer_load_dwordx4 v6, s[92:95], s12 offen nt lds
    s_waitcnt vmcnt(7)
    s_add_u32 m0, m0, 1024
    s_add_u32 s12, s12, s13
    buffer_load_dwordx4 v6, s[92:95], s12 offen nt lds
    s_waitcnt vmcnt(7)
    s_add_u32 m0, m0, 1024
    s_add_u32 s12, s12, s13
    buffer_load_dwordx4 v6, s[92:95], s12 offen nt lds
    s_waitcnt vmcnt(7)
    s_add_u32 m0, m0, 1024
    s_add_u32 s12, s12, s13
    buffer_load_dwordx4 v6, s[92:95], s12 offen nt lds
    s_waitcnt vmcnt(7)
    s_cmp_lg_u32 s3, 7
    s_cbranch_scc1 L_skip_29
    s_cmp_eq_u32 s97, 2
    s_cbranch_scc1 L_skip_29
    s_cmp_eq_u32 s97, 0
    s_cbranch_scc1 L_q1_30
    v_bitop3_b32 v56, v40, v41, s27 bitop3:0x7e
    v_bitop3_b32 v56, v56, v42, s27 bitop3:0xf6
    v_bitop3_b32 v56, v56, v43, s27 bitop3:0xf6
    v_bitop3_b32 v56, v56, v44, s27 bitop3:0xf6
    v_bitop3_b32 v56, v56, v45, s27 bitop3:0xf6
    v_bitop3_b32 v56, v56, v46, s27 bitop3:0xf6
    v_bitop3_b32 v56, v56, v47, s27 bitop3:0xf6
    v_bitop3_b32 v56, v56, v48, s27 bitop3:0xf6
    v_bitop3_b32 v56, v56, v49, s27 bitop3:0xf6
    v_bitop3_b32 v56, v56, v50, s27 bitop3:0xf6
    v_bitop3_b32 v56, v56, v51, s27 bitop3:0xf6
    v_bitop3_b32 v56, v56, v52, s27 bitop3:0xf6
    v_bitop3_b32 v56, v56, v53, s27 bitop3:0xf6
    v_bitop3_b32 v56, v56, v54, s27 bitop3:0xf6
    v_bitop3_b32 v56, v56, v55, s27 bitop3:0xf6
    v_cmp_ne_u16 vcc, 0, v56
    s_cbranch_vccz L_q3_31
L_q1_30:
    s_lshl_b32 s69, s47, 12
    s_add_u32 s69, s69, 32768
    s_mov_b32 s97, 1
    buffer_load_dwordx4 v[40:43], v2, s[48:51], s69 offen offset:0 sc1
    buffer_load_dwordx4 v[44:47], v2, s[48:51], s69 offen offset:1024 sc1
    buffer_load_dwordx4 v[48:51], v2, s[48:51], s69 offen offset:2048 sc1
    buffer_load_dwordx4 v[52:55], v2, s[48:51], s69 offen offset:3072 sc1
    s_branch L_skip_29
L_q3_31:
    v_lshlrev_b32 v56, 3, v0
    v_perm_b32 v8, v41, v40, s65
    v_perm_b32 v9, v43, v42, s65
    v_perm_b32 v10, v45, v44, s65
    v_perm_b32 v11, v47, v46, s65
    v_perm_b32 v12, v49, v48, s65
    v_perm_b32 v13, v51, v50, s65
    v_perm_b32 v14, v53, v52, s65
    v_perm_b32 v15, v55, v54, s65
    ds_write_b64 v56, v[8:9] offset:1024
    ds_write_b64 v56, v[10:11] offset:1536
    ds_write_b64 v56, v[12:13] offset:2048
    ds_write_b64 v56, v[14:15] offset:2560
    v_mov_b32 v56, 0
    v_mov_b32 v57, 1
    s_mov_b32 s97, 2
    s_waitcnt lgkmcnt(0)
    ds_write_b32 v56, v57 offset:3072
L_skip_29:
    s_add_u32 m0, m0, 1024
    s_nop 0
    buffer_load_dwordx4 v7, s[92:95], s14 offen nt lds
    s_waitcnt vmcnt(7)
    s_add_u32 m0, m0, 1024
    s_add_u32 s14, s14, s13
    buffer_load_dwordx4 v7, s[92:95], s14 offen nt lds
    s_waitcnt vmcnt(7)
    s_add_u32 m0, m0, 1024
    s_add_u32 s14, s14, s13
    buffer_load_dwordx4 v7, s[92:95], s14 offen nt lds
    s_waitcnt vmcnt(7)
    s_add_u32 m0, m0, 1024
    s_add_u32 s14, s14, s13
    buffer_load_dwordx4 v7, s[92:95], s14 offen nt lds
    s_waitcnt vmcnt(7)
    s_add_u32 m0, m0, 1024
    s_add_u32 s14, s14, s13
    buffer_load_dwordx4 v7, s[92:95], s14 offen nt lds
    s_waitcnt vmcnt(7)
    s_add_u32 m0, m0, 1024
    s_add_u32 s14, s14, s13
    buffer_load_dwordx4 v7, s[92:95], s14 offen nt lds
    s_waitcnt vmcnt(7)
    s_add_u32 m0, m0, 1024
    s_add_u32 s14, s14, s13
    buffer_load_dwordx4 v7, s[92:95], s14 offen nt lds
    s_waitcnt vmcnt(7)
    s_add_u32 m0, m0, 1024
    s_add_u32 s14, s14, s13
    buffer_load_dwordx4 v7, s[92:95], s14 offen nt lds
    s_cmp_lg_u32 s3, 7
    s_cbranch_scc1 L_skip_33
    s_mov_b32 s67, 262144
L_qtop_36:
    s_cmp_eq_u32 s97, 2
    s_cbranch_scc1 L_skip_33
    s_waitcnt vmcnt(0)
    s_sub_u32 s67, s67, 1
    s_cbranch_scc1 L_q3_35
    s_cmp_eq_u32 s97, 0
    s_cbranch_scc1 L_q1_34
    v_bitop3_b32 v56, v40, v41, s27 bitop3:0x7e
    v_bitop3_b32 v56, v56, v42, s27 bitop3:0xf6
    v_bitop3_b32 v56, v56, v43, s27 bitop3:0xf6
    v_bitop3_b32 v56, v56, v44, s27 bitop3:0xf6
    v_bitop3_b32 v56, v56, v45, s27 bitop3:0xf6
    v_bitop3_b32 v56, v56, v46, s27 bitop3:0xf6
    v_bitop3_b32 v56, v56, v47, s27 bitop3:0xf6
    v_bitop3_b32 v56, v56, v48, s27 bitop3:0xf6
    v_bitop3_b32 v56, v56, v49, s27 bitop3:0xf6
    v_bitop3_b32 v56, v56, v50, s27 bitop3:0xf6
    v_bitop3_b32 v56, v56, v51, s27 bitop3:0xf6
    v_bitop3_b32 v56, v56, v52, s27 bitop3:0xf6
    v_bitop3_b32 v56, v56, v53, s27 bitop3:0xf6
    v_bitop3_b32 v56, v56, v54, s27 bitop3:0xf6
    v_bitop3_b32 v56, v56, v55, s27 bitop3:0xf6
    v_cmp_ne_u16 vcc, 0, v56
    s_cbranch_vccz L_q3_35
    s_sleep 8
L_q1_34:
    s_lshl_b32 s69, s47, 12
    s_add_u32 s69, s69, 32768
    s_mov_b32 s97, 1
    buffer_load_dwordx4 v[40:43], v2, s[48:51], s69 offen offset:0 sc1
    buffer_load_dwordx4 v[44:47], v2, s[48:51], s69 offen offset:1024 sc1
    buffer_load_dwordx4 v[48:51], v2, s[48:51], s69 offen offset:2048 sc1
    buffer_load_dwordx4 v[52:55], v2, s[48:51], s69 offen offset:3072 sc1
    s_branch L_qtop_36
L_q3_35:
    v_lshlrev_b32 v56, 3, v0
    v_perm_b32 v8, v41, v40, s65
    v_perm_b32 v9, v43, v42, s65
    v_perm_b32 v10, v45, v44, s65
    v_perm_b32 v11, v47, v46, s65
    v_perm_b32 v12, v49, v48, s65
    v_perm_b32 v13, v51, v50, s65
    v_perm_b32 v14, v53, v52, s65
    v_perm_b32 v15, v55, v54, s65
    ds_write_b64 v56, v[8:9] offset:1024
    ds_write_b64 v56, v[10:11] offset:1536
    ds_write_b64 v56, v[12:13] offset:2048
    ds_write_b64 v56, v[14:15] offset:2560
    v_mov_b32 v56, 0
    v_mov_b32 v57, 1
    s_mov_b32 s97, 2
    s_waitcnt lgkmcnt(0)
    ds_write_b32 v56, v57 offset:3072
L_skip_33:
    v_mov_b32 v56, 0
    s_mov_b32 s67, 4194304
L_qf_37:
    ds_read_b32 v57, v56 offset:3072
    s_waitcnt lgkmcnt(0)
    v_cmp_eq_u32 vcc, 0, v57
    s_cbranch_vccz L_qfok_38
    s_sleep 2
    s_sub_u32 s67, s67, 1
    s_cbranch_scc0 L_qf_37
L_qfok_38:
    ds_read_b128 v[8:11], v3 offset:1024
    ds_read_b128 v[12:15], v3 offset:1152
    s_waitcnt lgkmcnt(0)
    v_mfma_f32_16x16x32_bf16 v[40:43], v[64:67], v[8:11], 0
    v_mfma_f32_16x16x32_bf16 v[44:47], v[72:75], v[8:11], 0
    v_mfma_f32_16x16x32_bf16 v[48:51], v[80:83], v[8:11], 0
    v_mfma_f32_16x16x32_bf16 v[52:55], v[88:91], v[8:11], 0
    v_mfma_f32_16x16x32_bf16 v[40:43], v[68:71], v[12:15], v[40:43]
    v_mfma_f32_16x16x32_bf16 v[44:47], v[76:79], v[12:15], v[44:47]
    v_mfma_f32_16x16x32_bf16 v[48:51], v[84:87], v[12:15], v[48:51]
    v_mfma_f32_16x16x32_bf16 v[52:55], v[92:95], v[12:15], v[52:55]
    s_nop 4
    v_add_f32_dpp v56, v41, v40 row_ror:8 row_mask:0xf bank_mask:0xf
    v_add_f32_dpp v57, v43, v42 row_ror:8 row_mask:0xf bank_mask:0xf
    v_cvt_pk_bf16_f32 v56, 0, v56
    v_cvt_pk_bf16_f32 v57, 0, v57
    v_mul_f32 v56, v56, v4
    v_mul_f32 v57, v57, v4
    v_max3_f32 v5, v5, v56, v57
    v_cvt_pk_bf16_f32 v16, v56, v57
    v_add_f32_dpp v58, v45, v44 row_ror:8 row_mask:0xf bank_mask:0xf
    v_add_f32_dpp v59, v47, v46 row_ror:8 row_mask:0xf bank_mask:0xf
    v_cvt_pk_bf16_f32 v58, 0, v58
    v_cvt_pk_bf16_f32 v59, 0, v59
    v_mul_f32 v58, v58, v4
    v_mul_f32 v59, v59, v4
    v_max3_f32 v5, v5, v58, v59
    v_cvt_pk_bf16_f32 v17, v58, v59
    v_add_f32_dpp v56, v49, v48 row_ror:8 row_mask:0xf bank_mask:0xf
    v_add_f32_dpp v57, v51, v50 row_ror:8 row_mask:0xf bank_mask:0xf
    v_cvt_pk_bf16_f32 v56, 0, v56
    v_cvt_pk_bf16_f32 v57, 0, v57
    v_mul_f32 v56, v56, v4
    v_mul_f32 v57, v57, v4
    v_max3_f32 v5, v5, v56, v57
    v_cvt_pk_bf16_f32 v18, v56, v57
    v_add_f32_dpp v58, v53, v52 row_ror:8 row_mask:0xf bank_mask:0xf
    v_add_f32_dpp v59, v55, v54 row_ror:8 row_mask:0xf bank_mask:0xf
    v_cvt_pk_bf16_f32 v58, 0, v58
    v_cvt_pk_bf16_f32 v59, 0, v59
    v_mul_f32 v58, v58, v4
    v_mul_f32 v59, v59, v4
    v_max3_f32 v5, v5, v58, v59
    v_cvt_pk_bf16_f32 v19, v58, v59
    v_mfma_f32_16x16x32_bf16 v[40:43], v[96:99], v[8:11], 0
    v_mfma_f32_16x16x32_bf16 v[44:47], v[104:107], v[8:11], 0
    v_mfma_f32_16x16x32_bf16 v[48:51], v[112:115], v[8:11], 0
    v_mfma_f32_16x16x32_bf16 v[52:55], v[120:123], v[8:11], 0
    v_mfma_f32_16x16x32_bf16 v[40:43], v[100:103], v[12:15], v[40:43]
    v_mfma_f32_16x16x32_bf16 v[44:47], v[108:111], v[12:15], v[44:47]
    v_mfma_f32_16x16x32_bf16 v[48:51], v[116:119], v[12:15], v[48:51]
    v_mfma_f32_16x16x32_bf16 v[52:55], v[124:127], v[12:15], v[52:55]
    s_nop 4
    v_add_f32_dpp v56, v41, v40 row_ror:8 row_mask:0xf bank_mask:0xf
    v_add_f32_dpp v57, v43, v42 row_ror:8 row_mask:0xf bank_mask:0xf
    v_cvt_pk_bf16_f32 v56, 0, v56
    v_cvt_pk_bf16_f32 v57, 0, v57
    v_mul_f32 v56, v56, v4
    v_mul_f32 v57, v57, v4
    v_max3_f32 v5, v5, v56, v57
    v_cvt_pk_bf16_f32 v20, v56, v57
    v_add_f32_dpp v58, v45, v44 row_ror:8 row_mask:0xf bank_mask:0xf
    v_add_f32_dpp v59, v47, v46 row_ror:8 row_mask:0xf bank_mask:0xf
    v_cvt_pk_bf16_f32 v58, 0, v58
    v_cvt_pk_bf16_f32 v59, 0, v59
    v_mul_f32 v58, v58, v4
    v_mul_f32 v59, v59, v4
    v_max3_f32 v5, v5, v58, v59
    v_cvt_pk_bf16_f32 v21, v58, v59
    v_add_f32_dpp v56, v49, v48 row_ror:8 row_mask:0xf bank_mask:0xf
    v_add_f32_dpp v57, v51, v50 row_ror:8 row_mask:0xf bank_mask:0xf
    v_cvt_pk_bf16_f32 v56, 0, v56
    v_cvt_pk_bf16_f32 v57, 0, v57
    v_mul_f32 v56, v56, v4
    v_mul_f32 v57, v57, v4
    v_max3_f32 v5, v5, v56, v57
    v_cvt_pk_bf16_f32 v22, v56, v57
    v_add_f32_dpp v58, v53, v52 row_ror:8 row_mask:0xf bank_mask:0xf
    v_add_f32_dpp v59, v55, v54 row_ror:8 row_mask:0xf bank_mask:0xf
    v_cvt_pk_bf16_f32 v58, 0, v58
    v_cvt_pk_bf16_f32 v59, 0, v59
    v_mul_f32 v58, v58, v4
    v_mul_f32 v59, v59, v4
    v_max3_f32 v5, v5, v58, v59
    v_cvt_pk_bf16_f32 v23, v58, v59
    buffer_load_dwordx4 v[96:99], v2, s[60:63], s4 offen offset:0 nt
    v_mfma_f32_16x16x32_bf16 v[40:43], v[128:131], v[8:11], 0
    v_mfma_f32_16x16x32_bf16 v[44:47], v[136:139], v[8:11], 0
    v_mfma_f32_16x16x32_bf16 v[48:51], v[144:147], v[8:11], 0
    v_mfma_f32_16x16x32_bf16 v[52:55], v[152:155], v[8:11], 0
    v_mfma_f32_16x16x32_bf16 v[40:43], v[132:135], v[12:15], v[40:43]
    v_mfma_f32_16x16x32_bf16 v[44:47], v[140:143], v[12:15], v[44:47]
    v_mfma_f32_16x16x32_bf16 v[48:51], v[148:151], v[12:15], v[48:51]
    v_mfma_f32_16x16x32_bf16 v[52:55], v[156:159], v[12:15], v[52:55]
    s_nop 4
    v_add_f32_dpp v56, v41, v40 row_ror:8 row_mask:0xf bank_mask:0xf
    v_add_f32_dpp v57, v43, v42 row_ror:8 row_mask:0xf bank_mask:0xf
    v_cvt_pk_bf16_f32 v56, 0, v56
    v_cvt_pk_bf16_f32 v57, 0, v57
    v_mul_f32 v56, v56, v4
    v_mul_f32 v57, v57, v4
    v_max3_f32 v5, v5, v56, v57
    v_cvt_pk_bf16_f32 v24, v56, v57
    v_add_f32_dpp v58, v45, v44 row_ror:8 row_mask:0xf bank_mask:0xf
    v_add_f32_dpp v59, v47, v46 row_ror:8 row_mask:0xf bank_mask:0xf
    v_cvt_pk_bf16_f32 v58, 0, v58
    v_cvt_pk_bf16_f32 v59, 0, v59
    v_mul_f32 v58, v58, v4
    v_mul_f32 v59, v59, v4
    v_max3_f32 v5, v5, v58, v59
    v_cvt_pk_bf16_f32 v25, v58, v59
    v_add_f32_dpp v56, v49, v48 row_ror:8 row_mask:0xf bank_mask:0xf
    v_add_f32_dpp v57, v51, v50 row_ror:8 row_mask:0xf bank_mask:0xf
    v_cvt_pk_bf16_f32 v56, 0, v56
    v_cvt_pk_bf16_f32 v57, 0, v57
    v_mul_f32 v56, v56, v4
    v_mul_f32 v57, v57, v4
    v_max3_f32 v5, v5, v56, v57
    v_cvt_pk_bf16_f32 v26, v56, v57
    v_add_f32_dpp v58, v53, v52 row_ror:8 row_mask:0xf bank_mask:0xf
    v_add_f32_dpp v59, v55, v54 row_ror:8 row_mask:0xf bank_mask:0xf
    v_cvt_pk_bf16_f32 v58, 0, v58
    v_cvt_pk_bf16_f32 v59, 0, v59
    v_mul_f32 v58, v58, v4
    v_mul_f32 v59, v59, v4
    v_max3_f32 v5, v5, v58, v59
    v_cvt_pk_bf16_f32 v27, v58, v59
    buffer_load_dwordx4 v[100:103], v2, s[60:63], s4 offen offset:1024 nt
    v_mfma_f32_16x16x32_bf16 v[40:43], v[160:163], v[8:11], 0
    v_mfma_f32_16x16x32_bf16 v[44:47], v[168:171], v[8:11], 0
    v_mfma_f32_16x16x32_bf16 v[48:51], v[176:179], v[8:11], 0
    v_mfma_f32_16x16x32_bf16 v[52:55], v[184:187], v[8:11], 0
    v_mfma_f32_16x16x32_bf16 v[40:43], v[164:167], v[12:15], v[40:43]
    v_mfma_f32_16x16x32_bf16 v[44:47], v[172:175], v[12:15], v[44:47]
    v_mfma_f32_16x16x32_bf16 v[48:51], v[180:183], v[12:15], v[48:51]
    v_mfma_f32_16x16x32_bf16 v[52:55], v[188:191], v[12:15], v[52:55]
    s_nop 4
    v_add_f32_dpp v56, v41, v40 row_ror:8 row_mask:0xf bank_mask:0xf
    v_add_f32_dpp v57, v43, v42 row_ror:8 row_mask:0xf bank_mask:0xf
    v_cvt_pk_bf16_f32 v56, 0, v56
    v_cvt_pk_bf16_f32 v57, 0, v57
    v_fma_f32 v56, v56, v4, s0
    v_fma_f32 v57, v57, v4, s0
    v_max3_f32 v5, v5, v56, v57
    v_cvt_pk_bf16_f32 v28, v56, v57
    v_add_f32_dpp v58, v45, v44 row_ror:8 row_mask:0xf bank_mask:0xf
    v_add_f32_dpp v59, v47, v46 row_ror:8 row_mask:0xf bank_mask:0xf
    v_cvt_pk_bf16_f32 v58, 0, v58
    v_cvt_pk_bf16_f32 v59, 0, v59
    v_fma_f32 v58, v58, v4, s0
    v_fma_f32 v59, v59, v4, s0
    v_max3_f32 v5, v5, v58, v59
    v_cvt_pk_bf16_f32 v29, v58, v59
    v_add_f32_dpp v56, v49, v48 row_ror:8 row_mask:0xf bank_mask:0xf
    v_add_f32_dpp v57, v51, v50 row_ror:8 row_mask:0xf bank_mask:0xf
    v_cvt_pk_bf16_f32 v56, 0, v56
    v_cvt_pk_bf16_f32 v57, 0, v57
    v_fma_f32 v56, v56, v4, s0
    v_fma_f32 v57, v57, v4, s0
    v_max3_f32 v5, v5, v56, v57
    v_cvt_pk_bf16_f32 v30, v56, v57
    v_add_f32_dpp v58, v53, v52 row_ror:8 row_mask:0xf bank_mask:0xf
    v_add_f32_dpp v59, v55, v54 row_ror:8 row_mask:0xf bank_mask:0xf
    v_cvt_pk_bf16_f32 v58, 0, v58
    v_cvt_pk_bf16_f32 v59, 0, v59
    v_fma_f32 v58, v58, v4, s0
    v_fma_f32 v59, v59, v4, s0
    v_max3_f32 v5, v5, v58, v59
    v_cvt_pk_bf16_f32 v31, v58, v59
    buffer_load_dwordx4 v[104:107], v2, s[60:63], s4 offen offset:2048 nt
    v_mfma_f32_16x16x32_bf16 v[40:43], v[192:195], v[8:11], 0
    v_mfma_f32_16x16x32_bf16 v[44:47], v[200:203], v[8:11], 0
    v_mfma_f32_16x16x32_bf16 v[48:51], v[208:211], v[8:11], 0
    v_mfma_f32_16x16x32_bf16 v[52:55], v[216:219], v[8:11], 0
    v_mfma_f32_16x16x32_bf16 v[40:43], v[196:199], v[12:15], v[40:43]
    v_mfma_f32_16x16x32_bf16 v[44:47], v[204:207], v[12:15], v[44:47]
    v_mfma_f32_16x16x32_bf16 v[48:51], v[212:215], v[12:15], v[48:51]
    v_mfma_f32_16x16x32_bf16 v[52:55], v[220:223], v[12:15], v[52:55]
    s_nop 4
    v_add_f32_dpp v56, v41, v40 row_ror:8 row_mask:0xf bank_mask:0xf
    v_add_f32_dpp v57, v43, v42 row_ror:8 row_mask:0xf bank_mask:0xf
    v_cvt_pk_bf16_f32 v56, 0, v56
    v_cvt_pk_bf16_f32 v57, 0, v57
    v_fma_f32 v56, v56, v4, s46
    v_fma_f32 v57, v57, v4, s46
    v_max3_f32 v5, v5, v56, v57
    v_cvt_pk_bf16_f32 v32, v56, v57
    v_add_f32_dpp v58, v45, v44 row_ror:8 row_mask:0xf bank_mask:0xf
    v_add_f32_dpp v59, v47, v46 row_ror:8 row_mask:0xf bank_mask:0xf
    v_cvt_pk_bf16_f32 v58, 0, v58
    v_cvt_pk_bf16_f32 v59, 0, v59
    v_fma_f32 v58, v58, v4, s46
    v_fma_f32 v59, v59, v4, s46
    v_max3_f32 v5, v5, v58, v59
    v_cvt_pk_bf16_f32 v33, v58, v59
    v_add_f32_dpp v56, v49, v48 row_ror:8 row_mask:0xf bank_mask:0xf
    v_add_f32_dpp v57, v51, v50 row_ror:8 row_mask:0xf bank_mask:0xf
    v_cvt_pk_bf16_f32 v56, 0, v56
    v_cvt_pk_bf16_f32 v57, 0, v57
    v_fma_f32 v56, v56, v4, s46
    v_fma_f32 v57, v57, v4, s46
    v_max3_f32 v5, v5, v56, v57
    v_cvt_pk_bf16_f32 v34, v56, v57
    v_add_f32_dpp v58, v53, v52 row_ror:8 row_mask:0xf bank_mask:0xf
    v_add_f32_dpp v59, v55, v54 row_ror:8 row_mask:0xf bank_mask:0xf
    v_cvt_pk_bf16_f32 v58, 0, v58
    v_cvt_pk_bf16_f32 v59, 0, v59
    v_fma_f32 v58, v58, v4, s46
    v_fma_f32 v59, v59, v4, s46
    v_max3_f32 v5, v5, v58, v59
    v_cvt_pk_bf16_f32 v35, v58, v59
    buffer_load_dwordx4 v[108:111], v2, s[60:63], s4 offen offset:3072 nt
    v_mfma_f32_16x16x32_bf16 v[40:43], v[224:227], v[8:11], 0
    v_mfma_f32_16x16x32_bf16 v[44:47], v[232:235], v[8:11], 0
    v_mfma_f32_16x16x32_bf16 v[48:51], v[240:243], v[8:11], 0
    v_mfma_f32_16x16x32_bf16 v[52:55], v[248:251], v[8:11], 0
    v_mfma_f32_16x16x32_bf16 v[40:43], v[228:231], v[12:15], v[40:43]
    v_mfma_f32_16x16x32_bf16 v[44:47], v[236:239], v[12:15], v[44:47]
    v_mfma_f32_16x16x32_bf16 v[48:51], v[244:247], v[12:15], v[48:51]
    v_mfma_f32_16x16x32_bf16 v[52:55], v[252:255], v[12:15], v[52:55]
    s_nop 4
    v_add_f32_dpp v56, v41, v40 row_ror:8 row_mask:0xf bank_mask:0xf
    v_add_f32_dpp v57, v43, v42 row_ror:8 row_mask:0xf bank_mask:0xf
    v_cvt_pk_bf16_f32 v56, 0, v56
    v_cvt_pk_bf16_f32 v57, 0, v57
    v_fma_f32 v56, v56, v4, s100
    v_fma_f32 v57, v57, v4, s100
    v_max3_f32 v5, v5, v56, v57
    v_cvt_pk_bf16_f32 v36, v56, v57
    v_add_f32_dpp v58, v45, v44 row_ror:8 row_mask:0xf bank_mask:0xf
    v_add_f32_dpp v59, v47, v46 row_ror:8 row_mask:0xf bank_mask:0xf
    v_cvt_pk_bf16_f32 v58, 0, v58
    v_cvt_pk_bf16_f32 v59, 0, v59
    v_fma_f32 v58, v58, v4, s100
    v_fma_f32 v59, v59, v4, s100
    v_max3_f32 v5, v5, v58, v59
    v_cvt_pk_bf16_f32 v37, v58, v59
    v_add_f32_dpp v56, v49, v48 row_ror:8 row_mask:0xf bank_mask:0xf
    v_add_f32_dpp v57, v51, v50 row_ror:8 row_mask:0xf bank_mask:0xf
    v_cvt_pk_bf16_f32 v56, 0, v56
    v_cvt_pk_bf16_f32 v57, 0, v57
    v_fma_f32 v56, v56, v4, s100
    v_fma_f32 v57, v57, v4, s100
    v_max3_f32 v5, v5, v56, v57
    v_cvt_pk_bf16_f32 v38, v56, v57
    v_add_f32_dpp v58, v53, v52 row_ror:8 row_mask:0xf bank_mask:0xf
    v_add_f32_dpp v59, v55, v54 row_ror:8 row_mask:0xf bank_mask:0xf
    v_cvt_pk_bf16_f32 v58, 0, v58
    v_cvt_pk_bf16_f32 v59, 0, v59
    v_fma_f32 v58, v58, v4, s100
    v_fma_f32 v59, v59, v4, s100
    v_max3_f32 v5, v5, v58, v59
    v_cvt_pk_bf16_f32 v39, v58, v59
    s_waitcnt vmcnt(11)
    buffer_load_dwordx4 v[112:115], v2, s[60:63], s5 offen offset:0 nt
    v_mov_b32 v56, v5
    s_nop 1
    v_permlane32_swap_b32 v5, v56
    v_max_f32 v5, v5, v56
    v_mov_b32 v56, v5
    s_nop 1
    v_permlane16_swap_b32 v5, v56
    v_max_f32 v5, v5, v56
    v_mov_b64 v[64:65], 0
    v_mov_b64 v[66:67], 0
    v_mov_b64 v[68:69], 0
    v_mov_b64 v[70:71], 0
    v_mov_b64 v[72:73], 0
    v_mov_b64 v[74:75], 0
    v_mov_b64 v[76:77], 0
    v_mov_b64 v[78:79], 0
    v_mov_b64 v[80:81], 0
    v_mov_b64 v[82:83], 0
    v_mov_b64 v[84:85], 0
    v_mov_b64 v[86:87], 0
    v_mov_b64 v[88:89], 0
    v_mov_b64 v[90:91], 0
    v_mov_b64 v[92:93], 0
    v_mov_b64 v[94:95], 0
    v_mov_b32 v4, 0x3fb8aa3b
    v_mov_b32 v60, 0
    v_cvt_pk_bf16_f32 v5, 0, v5
    v_mul_f32 v61, v5, v4
    s_waitcnt vmcnt(11)
    buffer_load_dwordx4 v[116:119], v2, s[60:63], s5 offen offset:1024 nt
    v_lshlrev_b32 v56, 16, v16
    v_and_b32 v57, s66, v16
    v_fma_f32 v56, v56, v4, -v61
    v_fma_f32 v57, v57, v4, -v61
    v_exp_f32 v56, v56
    v_exp_f32 v57, v57
    v_add_f32 v60, v60, v56
    v_add_f32 v60, v60, v57
    v_cvt_pk_bf16_f32 v16, v56, v57
    v_lshlrev_b32 v58, 16, v17
    v_and_b32 v59, s66, v17
    v_fma_f32 v58, v58, v4, -v61
    v_fma_f32 v59, v59, v4, -v61
    v_exp_f32 v58, v58
    v_exp_f32 v59, v59
    v_add_f32 v60, v60, v58
    v_add_f32 v60, v60, v59
    v_cvt_pk_bf16_f32 v17, v58, v59
    v_lshlrev_b32 v56, 16, v18
    v_and_b32 v57, s66, v18
    v_fma_f32 v56, v56, v4, -v61
    v_fma_f32 v57, v57, v4, -v61
    v_exp_f32 v56, v56
    v_exp_f32 v57, v57
    v_add_f32 v60, v60, v56
    v_add_f32 v60, v60, v57
    v_cvt_pk_bf16_f32 v18, v56, v57
    v_lshlrev_b32 v58, 16, v19
    v_and_b32 v59, s66, v19
    v_fma_f32 v58, v58, v4, -v61
    v_fma_f32 v59, v59, v4, -v61
    v_exp_f32 v58, v58
    v_exp_f32 v59, v59
    v_add_f32 v60, v60, v58
    v_add_f32 v60, v60, v59
    v_cvt_pk_bf16_f32 v19, v58, v59
    s_waitcnt vmcnt(11)
    buffer_load_dwordx4 v[120:123], v2, s[60:63], s5 offen offset:2048 nt
    v_lshlrev_b32 v56, 16, v20
    v_and_b32 v57, s66, v20
    v_fma_f32 v56, v56, v4, -v61
    v_fma_f32 v57, v57, v4, -v61
    v_exp_f32 v56, v56
    v_exp_f32 v57, v57
    v_add_f32 v60, v60, v56
    v_add_f32 v60, v60, v57
    v_cvt_pk_bf16_f32 v20, v56, v57
    v_lshlrev_b32 v58, 16, v21
    v_and_b32 v59, s66, v21
    v_fma_f32 v58, v58, v4, -v61
    v_fma_f32 v59, v59, v4, -v61
    v_exp_f32 v58, v58
    v_exp_f32 v59, v59
    v_add_f32 v60, v60, v58
    v_add_f32 v60, v60, v59
    v_cvt_pk_bf16_f32 v21, v58, v59
    v_lshlrev_b32 v56, 16, v22
    v_and_b32 v57, s66, v22
    v_fma_f32 v56, v56, v4, -v61
    v_fma_f32 v57, v57, v4, -v61
    v_exp_f32 v56, v56
    v_exp_f32 v57, v57
    v_add_f32 v60, v60, v56
    v_add_f32 v60, v60, v57
    v_cvt_pk_bf16_f32 v22, v56, v57
    v_lshlrev_b32 v58, 16, v23
    v_and_b32 v59, s66, v23
    v_fma_f32 v58, v58, v4, -v61
    v_fma_f32 v59, v59, v4, -v61
    v_exp_f32 v58, v58
    v_exp_f32 v59, v59
    v_add_f32 v60, v60, v58
    v_add_f32 v60, v60, v59
    v_cvt_pk_bf16_f32 v23, v58, v59
    s_waitcnt vmcnt(11)
    buffer_load_dwordx4 v[124:127], v2, s[60:63], s5 offen offset:3072 nt
    v_lshlrev_b32 v56, 16, v24
    v_and_b32 v57, s66, v24
    v_fma_f32 v56, v56, v4, -v61
    v_fma_f32 v57, v57, v4, -v61
    v_exp_f32 v56, v56
    v_exp_f32 v57, v57
    v_add_f32 v60, v60, v56
    v_add_f32 v60, v60, v57
    v_cvt_pk_bf16_f32 v24, v56, v57
    v_lshlrev_b32 v58, 16, v25
    v_and_b32 v59, s66, v25
    v_fma_f32 v58, v58, v4, -v61
    v_fma_f32 v59, v59, v4, -v61
    v_exp_f32 v58, v58
    v_exp_f32 v59, v59
    v_add_f32 v60, v60, v58
    v_add_f32 v60, v60, v59
    v_cvt_pk_bf16_f32 v25, v58, v59
    v_lshlrev_b32 v56, 16, v26
    v_and_b32 v57, s66, v26
    v_fma_f32 v56, v56, v4, -v61
    v_fma_f32 v57, v57, v4, -v61
    v_exp_f32 v56, v56
    v_exp_f32 v57, v57
    v_add_f32 v60, v60, v56
    v_add_f32 v60, v60, v57
    v_cvt_pk_bf16_f32 v26, v56, v57
    v_lshlrev_b32 v58, 16, v27
    v_and_b32 v59, s66, v27
    v_fma_f32 v58, v58, v4, -v61
    v_fma_f32 v59, v59, v4, -v61
    v_exp_f32 v58, v58
    v_exp_f32 v59, v59
    v_add_f32 v60, v60, v58
    v_add_f32 v60, v60, v59
    v_cvt_pk_bf16_f32 v27, v58, v59
    s_waitcnt vmcnt(11)
    buffer_load_dwordx4 v[128:131], v2, s[60:63], s6 offen offset:0 nt
    v_lshlrev_b32 v56, 16, v28
    v_and_b32 v57, s66, v28
    v_fma_f32 v56, v56, v4, -v61
    v_fma_f32 v57, v57, v4, -v61
    v_exp_f32 v56, v56
    v_exp_f32 v57, v57
    v_add_f32 v60, v60, v56
    v_add_f32 v60, v60, v57
    v_cvt_pk_bf16_f32 v28, v56, v57
    v_lshlrev_b32 v58, 16, v29
    v_and_b32 v59, s66, v29
    v_fma_f32 v58, v58, v4, -v61
    v_fma_f32 v59, v59, v4, -v61
    v_exp_f32 v58, v58
    v_exp_f32 v59, v59
    v_add_f32 v60, v60, v58
    v_add_f32 v60, v60, v59
    v_cvt_pk_bf16_f32 v29, v58, v59
    v_lshlrev_b32 v56, 16, v30
    v_and_b32 v57, s66, v30
    v_fma_f32 v56, v56, v4, -v61
    v_fma_f32 v57, v57, v4, -v61
    v_exp_f32 v56, v56
    v_exp_f32 v57, v57
    v_add_f32 v60, v60, v56
    v_add_f32 v60, v60, v57
    v_cvt_pk_bf16_f32 v30, v56, v57
    v_lshlrev_b32 v58, 16, v31
    v_and_b32 v59, s66, v31
    v_fma_f32 v58, v58, v4, -v61
    v_fma_f32 v59, v59, v4, -v61
    v_exp_f32 v58, v58
    v_exp_f32 v59, v59
    v_add_f32 v60, v60, v58
    v_add_f32 v60, v60, v59
    v_cvt_pk_bf16_f32 v31, v58, v59
    s_waitcnt vmcnt(11)
    buffer_load_dwordx4 v[132:135], v2, s[60:63], s6 offen offset:1024 nt
    v_lshlrev_b32 v56, 16, v32
    v_and_b32 v57, s66, v32
    v_fma_f32 v56, v56, v4, -v61
    v_fma_f32 v57, v57, v4, -v61
    v_exp_f32 v56, v56
    v_exp_f32 v57, v57
    v_add_f32 v60, v60, v56
    v_add_f32 v60, v60, v57
    v_cvt_pk_bf16_f32 v32, v56, v57
    v_lshlrev_b32 v58, 16, v33
    v_and_b32 v59, s66, v33
    v_fma_f32 v58, v58, v4, -v61
    v_fma_f32 v59, v59, v4, -v61
    v_exp_f32 v58, v58
    v_exp_f32 v59, v59
    v_add_f32 v60, v60, v58
    v_add_f32 v60, v60, v59
    v_cvt_pk_bf16_f32 v33, v58, v59
    v_lshlrev_b32 v56, 16, v34
    v_and_b32 v57, s66, v34
    v_fma_f32 v56, v56, v4, -v61
    v_fma_f32 v57, v57, v4, -v61
    v_exp_f32 v56, v56
    v_exp_f32 v57, v57
    v_add_f32 v60, v60, v56
    v_add_f32 v60, v60, v57
    v_cvt_pk_bf16_f32 v34, v56, v57
    v_lshlrev_b32 v58, 16, v35
    v_and_b32 v59, s66, v35
    v_fma_f32 v58, v58, v4, -v61
    v_fma_f32 v59, v59, v4, -v61
    v_exp_f32 v58, v58
    v_exp_f32 v59, v59
    v_add_f32 v60, v60, v58
    v_add_f32 v60, v60, v59
    v_cvt_pk_bf16_f32 v35, v58, v59
    s_waitcnt vmcnt(11)
    buffer_load_dwordx4 v[136:139], v2, s[60:63], s6 offen offset:2048 nt
    v_lshlrev_b32 v56, 16, v36
    v_and_b32 v57, s66, v36
    v_fma_f32 v56, v56, v4, -v61
    v_fma_f32 v57, v57, v4, -v61
    v_exp_f32 v56, v56
    v_exp_f32 v57, v57
    v_add_f32 v60, v60, v56
    v_add_f32 v60, v60, v57
    v_cvt_pk_bf16_f32 v36, v56, v57
    v_lshlrev_b32 v58, 16, v37
    v_and_b32 v59, s66, v37
    v_fma_f32 v58, v58, v4, -v61
    v_fma_f32 v59, v59, v4, -v61
    v_exp_f32 v58, v58
    v_exp_f32 v59, v59
    v_add_f32 v60, v60, v58
    v_add_f32 v60, v60, v59
    v_cvt_pk_bf16_f32 v37, v58, v59
    v_lshlrev_b32 v56, 16, v38
    v_and_b32 v57, s66, v38
    v_fma_f32 v56, v56, v4, -v61
    v_fma_f32 v57, v57, v4, -v61
    v_exp_f32 v56, v56
    v_exp_f32 v57, v57
    v_add_f32 v60, v60, v56
    v_add_f32 v60, v60, v57
    v_cvt_pk_bf16_f32 v38, v56, v57
    v_lshlrev_b32 v58, 16, v39
    v_and_b32 v59, s66, v39
    v_fma_f32 v58, v58, v4, -v61
    v_fma_f32 v59, v59, v4, -v61
    v_exp_f32 v58, v58
    v_exp_f32 v59, v59
    v_add_f32 v60, v60, v58
    v_add_f32 v60, v60, v59
    v_cvt_pk_bf16_f32 v39, v58, v59
    v_mov_b32 v56, v60
    s_nop 1
    v_permlane32_swap_b32 v60, v56
    v_add_f32 v60, v60, v56
    v_mov_b32 v56, v60
    s_nop 1
    v_permlane16_swap_b32 v60, v56
    v_add_f32 v60, v60, v56
    s_lshl_b32 s69, s3, 3
    v_add_u32 v56, s69, v63
    v_mov_b32 v58, v5
    v_min_u32 v59, -2, v60
    ds_write_b64 v56, v[58:59] offset:0
    s_waitcnt vmcnt(11)
    buffer_load_dwordx4 v[140:143], v2, s[60:63], s6 offen offset:3072 nt
    s_cmp_lg_u32 s3, 4
    s_cbranch_scc1 L_skip_39
    s_mov_b32 s67, 4194304
L_ml_40:
    ds_read_b128 v[40:43], v63 offset:0
    ds_read_b128 v[44:47], v63 offset:16
    ds_read_b128 v[48:51], v63 offset:32
    ds_read_b128 v[52:55], v63 offset:48
    s_waitcnt lgkmcnt(0)
    v_max_u32 v56, v41, v43
    v_max3_u32 v56, v56, v45, v47
    v_max3_u32 v56, v56, v49, v51
    v_max3_u32 v56, v56, v53, v55
    v_cmp_eq_u32 vcc, -1, v56
    s_cbranch_vccz L_mlok_41
    s_sleep 2
    s_sub_u32 s67, s67, 1
    s_cbranch_scc0 L_ml_40
L_mlok_41:
    v_max_f32 v58, v40, v42
    v_max3_f32 v58, v58, v44, v46
    v_max3_f32 v58, v58, v48, v50
    v_max3_f32 v58, v58, v52, v54
    v_mov_b32 v59, 0
    v_sub_f32 v40, v40, v58
    v_mul_f32 v40, 0x3fb8aa3b, v40
    v_sub_f32 v42, v42, v58
    v_mul_f32 v42, 0x3fb8aa3b, v42
    v_sub_f32 v44, v44, v58
    v_mul_f32 v44, 0x3fb8aa3b, v44
    v_sub_f32 v46, v46, v58
    v_mul_f32 v46, 0x3fb8aa3b, v46
    v_sub_f32 v48, v48, v58
    v_mul_f32 v48, 0x3fb8aa3b, v48
    v_sub_f32 v50, v50, v58
    v_mul_f32 v50, 0x3fb8aa3b, v50
    v_sub_f32 v52, v52, v58
    v_mul_f32 v52, 0x3fb8aa3b, v52
    v_sub_f32 v54, v54, v58
    v_mul_f32 v54, 0x3fb8aa3b, v54
    v_exp_f32 v40, v40
    v_exp_f32 v42, v42
    v_exp_f32 v44, v44
    v_exp_f32 v46, v46
    v_exp_f32 v48, v48
    v_exp_f32 v50, v50
    v_exp_f32 v52, v52
    v_exp_f32 v54, v54
    s_lshl_b32 s69, s47, 11
    s_lshl_b32 s98, s68, 3
    s_add_u32 s69, s69, s98
    s_add_u32 s69, s69, 65536
    v_fmac_f32 v59, v40, v41
    v_fmac_f32 v59, v42, v43
    v_fmac_f32 v59, v44, v45
    v_fmac_f32 v59, v46, v47
    v_fmac_f32 v59, v48, v49
    v_fmac_f32 v59, v50, v51
    v_fmac_f32 v59, v52, v53
    v_fmac_f32 v59, v54, v55
    v_lshlrev_b32 v56, 8, v0
    v_mov_b32 v57, 0xffffff00
    v_or_b32 v58, s1, v58
    v_and_or_b32 v59, v59, v57, s26
    s_mov_b64 exec, 0xff
    buffer_store_dwordx2 v[58:59], v56, s[48:51], s69 offen sc1
    s_mov_b64 exec, -1
L_skip_39:
    s_waitcnt vmcnt(11)
    buffer_load_dwordx4 v[144:147], v2, s[60:63], s7 offen offset:0 nt
    s_mul_i32 s69, s3, 16384
    s_add_u32 s69, s69, 4096
    v_bfe_u32 v1, v0, 4, 2
    v_lshlrev_b32 v1, 7, v1
    v_and_b32 v56, 15, v0
    v_lshl_add_u32 v1, v56, 4, v1
    v_add_u32 v1, s69, v1
    s_lshl_b32 s69, s3, 4
    s_add_u32 s69, s69, 4096
    v_bfe_u32 v3, v0, 1, 3
    v_mul_u32_u24 v3, 528, v3
    v_bfe_u32 v56, v0, 4, 2
    v_lshl_add_u32 v3, v56, 7, v3
    v_and_b32 v56, 1, v0
    v_lshl_add_u32 v3, v56, 3, v3
    v_add_u32 v3, s69, v3
    v_add_u32 v4, 65536, v3
    s_lshl_b32 s69, s3, 14
    s_add_u32 s69, s69, 4096
    v_add_u32 v56, s69, v2
    s_cmp_ge_u32 s68, 17
    s_cbranch_scc1 L_w1_42
    ds_read_b128 v[192:195], v56 offset:0
    ds_read_b128 v[196:199], v56 offset:1024
    ds_read_b128 v[200:203], v56 offset:2048
    ds_read_b128 v[204:207], v56 offset:3072
    ds_read_b128 v[208:211], v56 offset:4096
    ds_read_b128 v[212:215], v56 offset:5120
    ds_read_b128 v[216:219], v56 offset:6144
    ds_read_b128 v[220:223], v56 offset:7168
    ds_read_b128 v[224:227], v56 offset:8192
    ds_read_b128 v[228:231], v56 offset:9216
    ds_read_b128 v[232:235], v56 offset:10240
    ds_read_b128 v[236:239], v56 offset:11264
    ds_read_b128 v[240:243], v56 offset:12288
    ds_read_b128 v[244:247], v56 offset:13312
    ds_read_b128 v[248:251], v56 offset:14336
    ds_read_b128 v[252:255], v56 offset:15360
    s_waitcnt lgkmcnt(8)
    v_perm_b32 v40, v196, v192, s64
    v_perm_b32 v41, v204, v200, s64
    v_perm_b32 v42, v212, v208, s64
    v_perm_b32 v43, v220, v216, s64
    v_perm_b32 v44, v196, v192, s65
    v_perm_b32 v45, v204, v200, s65
    v_perm_b32 v46, v212, v208, s65
    v_perm_b32 v47, v220, v216, s65
    v_mfma_f32_16x16x32_bf16 v[64:67], v[40:43], v[32:35], v[64:67]
    s_nop 0
    v_mfma_f32_16x16x32_bf16 v[68:71], v[44:47], v[32:35], v[68:71]
    v_perm_b32 v48, v197, v193, s64
    v_perm_b32 v49, v205, v201, s64
    v_perm_b32 v50, v213, v209, s64
    v_perm_b32 v51, v221, v217, s64
    v_perm_b32 v52, v197, v193, s65
    v_perm_b32 v53, v205, v201, s65
    v_perm_b32 v54, v213, v209, s65
    v_perm_b32 v55, v221, v217, s65
    v_mfma_f32_16x16x32_bf16 v[72:75], v[48:51], v[32:35], v[72:75]
    s_nop 0
    v_mfma_f32_16x16x32_bf16 v[76:79], v[52:55], v[32:35], v[76:79]
    v_perm_b32 v40, v198, v194, s64
    v_perm_b32 v41, v206, v202, s64
    v_perm_b32 v42, v214, v210, s64
    v_perm_b32 v43, v222, v218, s64
    v_perm_b32 v44, v198, v194, s65
    v_perm_b32 v45, v206, v202, s65
    v_perm_b32 v46, v214, v210, s65
    v_perm_b32 v47, v222, v218, s65
    v_mfma_f32_16x16x32_bf16 v[80:83], v[40:43], v[32:35], v[80:83]
    s_nop 0
    v_mfma_f32_16x16x32_bf16 v[84:87], v[44:47], v[32:35], v[84:87]
    v_perm_b32 v48, v199, v195, s64
    v_perm_b32 v49, v207, v203, s64
    v_perm_b32 v50, v215, v211, s64
    v_perm_b32 v51, v223, v219, s64
    v_perm_b32 v52, v199, v195, s65
    v_perm_b32 v53, v207, v203, s65
    v_perm_b32 v54, v215, v211, s65
    v_perm_b32 v55, v223, v219, s65
    v_mfma_f32_16x16x32_bf16 v[88:91], v[48:51], v[32:35], v[88:91]
    s_nop 0
    v_mfma_f32_16x16x32_bf16 v[92:95], v[52:55], v[32:35], v[92:95]
    s_waitcnt lgkmcnt(0)
    v_perm_b32 v40, v228, v224, s64
    v_perm_b32 v41, v236, v232, s64
    v_perm_b32 v42, v244, v240, s64
    v_perm_b32 v43, v252, v248, s64
    v_perm_b32 v44, v228, v224, s65
    v_perm_b32 v45, v236, v232, s65
    v_perm_b32 v46, v244, v240, s65
    v_perm_b32 v47, v252, v248, s65
    v_mfma_f32_16x16x32_bf16 v[64:67], v[40:43], v[36:39], v[64:67]
    s_nop 0
    v_mfma_f32_16x16x32_bf16 v[68:71], v[44:47], v[36:39], v[68:71]
    v_perm_b32 v48, v229, v225, s64
    v_perm_b32 v49, v237, v233, s64
    v_perm_b32 v50, v245, v241, s64
    v_perm_b32 v51, v253, v249, s64
    v_perm_b32 v52, v229, v225, s65
    v_perm_b32 v53, v237, v233, s65
    v_perm_b32 v54, v245, v241, s65
    v_perm_b32 v55, v253, v249, s65
    v_mfma_f32_16x16x32_bf16 v[72:75], v[48:51], v[36:39], v[72:75]
    s_nop 0
    v_mfma_f32_16x16x32_bf16 v[76:79], v[52:55], v[36:39], v[76:79]
    v_perm_b32 v40, v230, v226, s64
    v_perm_b32 v41, v238, v234, s64
    v_perm_b32 v42, v246, v242, s64
    v_perm_b32 v43, v254, v250, s64
    v_perm_b32 v44, v230, v226, s65
    v_perm_b32 v45, v238, v234, s65
    v_perm_b32 v46, v246, v242, s65
    v_perm_b32 v47, v254, v250, s65
    v_mfma_f32_16x16x32_bf16 v[80:83], v[40:43], v[36:39], v[80:83]
    s_nop 0
    v_mfma_f32_16x16x32_bf16 v[84:87], v[44:47], v[36:39], v[84:87]
    v_perm_b32 v48, v231, v227, s64
    v_perm_b32 v49, v239, v235, s64
    v_perm_b32 v50, v247, v243, s64
    v_perm_b32 v51, v255, v251, s64
    v_perm_b32 v52, v231, v227, s65
    v_perm_b32 v53, v239, v235, s65
    v_perm_b32 v54, v247, v243, s65
    v_perm_b32 v55, v255, v251, s65
    v_mfma_f32_16x16x32_bf16 v[88:91], v[48:51], v[36:39], v[88:91]
    s_nop 0
    v_mfma_f32_16x16x32_bf16 v[92:95], v[52:55], v[36:39], v[92:95]
    s_branch L_w1j_43
L_w1_42:
    v_perm_b32 v40, v228, v224, s64
    v_perm_b32 v41, v236, v232, s64
    v_perm_b32 v42, v244, v240, s64
    v_perm_b32 v43, v252, v248, s64
    v_perm_b32 v44, v228, v224, s65
    v_perm_b32 v45, v236, v232, s65
    v_perm_b32 v46, v244, v240, s65
    v_perm_b32 v47, v252, v248, s65
    v_mfma_f32_16x16x32_bf16 v[64:67], v[40:43], v[32:35], v[64:67]
    s_nop 0
    v_mfma_f32_16x16x32_bf16 v[68:71], v[44:47], v[32:35], v[68:71]
    v_perm_b32 v48, v229, v225, s64
    v_perm_b32 v49, v237, v233, s64
    v_perm_b32 v50, v245, v241, s64
    v_perm_b32 v51, v253, v249, s64
    v_perm_b32 v52, v229, v225, s65
    v_perm_b32 v53, v237, v233, s65
    v_perm_b32 v54, v245, v241, s65
    v_perm_b32 v55, v253, v249, s65
    v_mfma_f32_16x16x32_bf16 v[72:75], v[48:51], v[32:35], v[72:75]
    s_nop 0
    v_mfma_f32_16x16x32_bf16 v[76:79], v[52:55], v[32:35], v[76:79]
    v_perm_b32 v40, v230, v226, s64
    v_perm_b32 v41, v238, v234, s64
    v_perm_b32 v42, v246, v242, s64
    v_perm_b32 v43, v254, v250, s64
    v_perm_b32 v44, v230, v226, s65
    v_perm_b32 v45, v238, v234, s65
    v_perm_b32 v46, v246, v242, s65
    v_perm_b32 v47, v254, v250, s65
    v_mfma_f32_16x16x32_bf16 v[80:83], v[40:43], v[32:35], v[80:83]
    s_nop 0
    v_mfma_f32_16x16x32_bf16 v[84:87], v[44:47], v[32:35], v[84:87]
    v_perm_b32 v48, v231, v227, s64
    v_perm_b32 v49, v239, v235, s64
    v_perm_b32 v50, v247, v243, s64
    v_perm_b32 v51, v255, v251, s64
    v_perm_b32 v52, v231, v227, s65
    v_perm_b32 v53, v239, v235, s65
    v_perm_b32 v54, v247, v243, s65
    v_perm_b32 v55, v255, v251, s65
    v_mfma_f32_16x16x32_bf16 v[88:91], v[48:51], v[32:35], v[88:91]
    s_nop 0
    v_mfma_f32_16x16x32_bf16 v[92:95], v[52:55], v[32:35], v[92:95]
    ds_read_b128 v[192:195], v56 offset:0
    ds_read_b128 v[200:203], v56 offset:1024
    ds_read_b128 v[208:211], v56 offset:2048
    ds_read_b128 v[216:219], v56 offset:3072
    ds_read_b128 v[224:227], v56 offset:4096
    ds_read_b128 v[232:235], v56 offset:5120
    ds_read_b128 v[240:243], v56 offset:6144
    ds_read_b128 v[248:251], v56 offset:7168
    ds_read_b128 v[196:199], v56 offset:8192
    ds_read_b128 v[204:207], v56 offset:9216
    ds_read_b128 v[212:215], v56 offset:10240
    ds_read_b128 v[220:223], v56 offset:11264
    ds_read_b128 v[228:231], v56 offset:12288
    ds_read_b128 v[236:239], v56 offset:13312
    ds_read_b128 v[244:247], v56 offset:14336
    ds_read_b128 v[252:255], v56 offset:15360
    s_waitcnt lgkmcnt(8)
    v_perm_b32 v56, v200, v192, s64
    v_perm_b32 v200, v200, v192, s65
    v_mov_b32 v192, v56
    v_perm_b32 v56, v217, v209, s64
    v_perm_b32 v217, v217, v209, s65
    v_mov_b32 v209, v56
    v_perm_b32 v56, v234, v226, s64
    v_perm_b32 v234, v234, v226, s65
    v_mov_b32 v226, v56
    v_perm_b32 v56, v251, v243, s64
    v_perm_b32 v251, v251, v243, s65
    v_mov_b32 v243, v56
    v_perm_b32 v56, v201, v193, s64
    v_perm_b32 v57, v201, v193, s65
    v_perm_b32 v193, v216, v208, s64
    v_perm_b32 v201, v216, v208, s65
    v_mov_b32 v208, v56
    v_mov_b32 v216, v57
    v_perm_b32 v56, v202, v194, s64
    v_perm_b32 v57, v202, v194, s65
    v_perm_b32 v194, v232, v224, s64
    v_perm_b32 v202, v232, v224, s65
    v_mov_b32 v224, v56
    v_mov_b32 v232, v57
    v_perm_b32 v56, v203, v195, s64
    v_perm_b32 v57, v203, v195, s65
    v_perm_b32 v195, v248, v240, s64
    v_perm_b32 v203, v248, v240, s65
    v_mov_b32 v240, v56
    v_mov_b32 v248, v57
    v_perm_b32 v56, v218, v210, s64
    v_perm_b32 v57, v218, v210, s65
    v_perm_b32 v210, v233, v225, s64
    v_perm_b32 v218, v233, v225, s65
    v_mov_b32 v225, v56
    v_mov_b32 v233, v57
    v_perm_b32 v56, v219, v211, s64
    v_perm_b32 v57, v219, v211, s65
    v_perm_b32 v211, v249, v241, s64
    v_perm_b32 v219, v249, v241, s65
    v_mov_b32 v241, v56
    v_mov_b32 v249, v57
    v_perm_b32 v56, v235, v227, s64
    v_perm_b32 v57, v235, v227, s65
    v_perm_b32 v227, v250, v242, s64
    v_perm_b32 v235, v250, v242, s65
    v_mov_b32 v242, v56
    v_mov_b32 v250, v57
    s_waitcnt lgkmcnt(0)
    v_perm_b32 v56, v204, v196, s64
    v_perm_b32 v204, v204, v196, s65
    v_mov_b32 v196, v56
    v_perm_b32 v56, v221, v213, s64
    v_perm_b32 v221, v221, v213, s65
    v_mov_b32 v213, v56
    v_perm_b32 v56, v238, v230, s64
    v_perm_b32 v238, v238, v230, s65
    v_mov_b32 v230, v56
    v_perm_b32 v56, v255, v247, s64
    v_perm_b32 v255, v255, v247, s65
    v_mov_b32 v247, v56
    v_perm_b32 v56, v205, v197, s64
    v_perm_b32 v57, v205, v197, s65
    v_perm_b32 v197, v220, v212, s64
    v_perm_b32 v205, v220, v212, s65
    v_mov_b32 v212, v56
    v_mov_b32 v220, v57
    v_perm_b32 v56, v206, v198, s64
    v_perm_b32 v57, v206, v198, s65
    v_perm_b32 v198, v236, v228, s64
    v_perm_b32 v206, v236, v228, s65
    v_mov_b32 v228, v56
    v_mov_b32 v236, v57
    v_perm_b32 v56, v207, v199, s64
    v_perm_b32 v57, v207, v199, s65
    v_perm_b32 v199, v252, v244, s64
    v_perm_b32 v207, v252, v244, s65
    v_mov_b32 v244, v56
    v_mov_b32 v252, v57
    v_perm_b32 v56, v222, v214, s64
    v_perm_b32 v57, v222, v214, s65
    v_perm_b32 v214, v237, v229, s64
    v_perm_b32 v222, v237, v229, s65
    v_mov_b32 v229, v56
    v_mov_b32 v237, v57
    v_perm_b32 v56, v223, v215, s64
    v_perm_b32 v57, v223, v215, s65
    v_perm_b32 v215, v253, v245, s64
    v_perm_b32 v223, v253, v245, s65
    v_mov_b32 v245, v56
    v_mov_b32 v253, v57
    v_perm_b32 v56, v239, v231, s64
    v_perm_b32 v57, v239, v231, s65
    v_perm_b32 v231, v254, v246, s64
    v_perm_b32 v239, v254, v246, s65
    v_mov_b32 v246, v56
    v_mov_b32 v254, v57
L_w1j_43:
    s_waitcnt vmcnt(11)
    buffer_load_dwordx4 v[148:151], v2, s[60:63], s7 offen offset:1024 nt
    s_waitcnt vmcnt(11)
    buffer_load_dwordx4 v[152:155], v2, s[60:63], s7 offen offset:2048 nt
    s_waitcnt vmcnt(11)
    buffer_load_dwordx4 v[156:159], v2, s[60:63], s7 offen offset:3072 nt
    s_waitcnt vmcnt(11)
    buffer_load_dwordx4 v[160:163], v2, s[60:63], s8 offen offset:0 nt
    s_cmp_lt_u32 s68, 17
    s_cbranch_scc1 L_nomld_44
    s_lshl_b32 s69, s3, 6
    v_add_u32 v56, s69, v0
    v_bfe_u32 v57, v56, 8, 1
    v_lshlrev_b32 v57, 14, v57
    v_and_b32 v58, 255, v56
    v_lshl_add_u32 v57, v58, 4, v57
    v_add_u32 v57, 266240, v57
    s_lshl_b32 s98, s3, 14
    s_add_u32 m0, s98, 12288
    s_mov_b32 s69, 0
    buffer_load_dwordx4 v57, s[48:51], s69 offen sc1 lds
    s_add_u32 m0, m0, 1024
    s_mov_b32 s69, 32768
    buffer_load_dwordx4 v57, s[48:51], s69 offen sc1 lds
    s_add_u32 m0, m0, 1024
    s_mov_b32 s69, 4096
    buffer_load_dwordx4 v57, s[48:51], s69 offen sc1 lds
    s_add_u32 m0, m0, 1024
    s_mov_b32 s69, 36864
    buffer_load_dwordx4 v57, s[48:51], s69 offen sc1 lds
    s_add_u32 m0, m0, 1024
L_nomld_44:
    s_waitcnt vmcnt(11)
    buffer_load_dwordx4 v[164:167], v2, s[60:63], s8 offen offset:1024 nt
    s_waitcnt vmcnt(11)
    buffer_load_dwordx4 v[168:171], v2, s[60:63], s8 offen offset:2048 nt
    s_waitcnt vmcnt(11)
    buffer_load_dwordx4 v[172:175], v2, s[60:63], s8 offen offset:3072 nt
    v_perm_b32 v40, v100, v96, s64
    v_perm_b32 v41, v108, v104, s64
    v_perm_b32 v42, v116, v112, s64
    v_perm_b32 v43, v124, v120, s64
    v_perm_b32 v44, v100, v96, s65
    v_perm_b32 v45, v108, v104, s65
    v_perm_b32 v46, v116, v112, s65
    v_perm_b32 v47, v124, v120, s65
    v_mfma_f32_16x16x32_bf16 v[64:67], v[40:43], v[16:19], v[64:67]
    s_nop 0
    v_mfma_f32_16x16x32_bf16 v[68:71], v[44:47], v[16:19], v[68:71]
    v_perm_b32 v48, v101, v97, s64
    v_perm_b32 v49, v109, v105, s64
    v_perm_b32 v50, v117, v113, s64
    v_perm_b32 v51, v125, v121, s64
    v_perm_b32 v52, v101, v97, s65
    v_perm_b32 v53, v109, v105, s65
    v_perm_b32 v54, v117, v113, s65
    v_perm_b32 v55, v125, v121, s65
    v_mfma_f32_16x16x32_bf16 v[72:75], v[48:51], v[16:19], v[72:75]
    s_nop 0
    v_mfma_f32_16x16x32_bf16 v[76:79], v[52:55], v[16:19], v[76:79]
    v_perm_b32 v40, v102, v98, s64
    v_perm_b32 v41, v110, v106, s64
    v_perm_b32 v42, v118, v114, s64
    v_perm_b32 v43, v126, v122, s64
    v_perm_b32 v44, v102, v98, s65
    v_perm_b32 v45, v110, v106, s65
    v_perm_b32 v46, v118, v114, s65
    v_perm_b32 v47, v126, v122, s65
    v_mfma_f32_16x16x32_bf16 v[80:83], v[40:43], v[16:19], v[80:83]
    s_nop 0
    v_mfma_f32_16x16x32_bf16 v[84:87], v[44:47], v[16:19], v[84:87]
    v_perm_b32 v48, v103, v99, s64
    v_perm_b32 v49, v111, v107, s64
    v_perm_b32 v50, v119, v115, s64
    v_perm_b32 v51, v127, v123, s64
    v_perm_b32 v52, v103, v99, s65
    v_perm_b32 v53, v111, v107, s65
    v_perm_b32 v54, v119, v115, s65
    v_perm_b32 v55, v127, v123, s65
    v_mfma_f32_16x16x32_bf16 v[88:91], v[48:51], v[16:19], v[88:91]
    s_nop 0
    v_mfma_f32_16x16x32_bf16 v[92:95], v[52:55], v[16:19], v[92:95]
    s_waitcnt vmcnt(11)
    buffer_load_dwordx4 v[176:179], v2, s[60:63], s9 offen offset:0 nt
    s_waitcnt vmcnt(11)
    buffer_load_dwordx4 v[180:183], v2, s[60:63], s9 offen offset:1024 nt
    s_waitcnt vmcnt(11)
    buffer_load_dwordx4 v[184:187], v2, s[60:63], s9 offen offset:2048 nt
    s_waitcnt vmcnt(11)
    buffer_load_dwordx4 v[188:191], v2, s[60:63], s9 offen offset:3072 nt
    s_waitcnt vmcnt(11)
    v_add_u32 v6, s43, v2
    buffer_load_dwordx4 v[96:99], v6, s[60:63], s10 offen offset:0 nt
    s_waitcnt vmcnt(11)
    buffer_load_dwordx4 v[100:103], v6, s[60:63], s10 offen offset:1024 nt
    s_waitcnt vmcnt(11)
    buffer_load_dwordx4 v[104:107], v6, s[60:63], s10 offen offset:2048 nt
    s_waitcnt vmcnt(11)
    buffer_load_dwordx4 v[108:111], v6, s[60:63], s10 offen offset:3072 nt
    v_perm_b32 v40, v132, v128, s64
    v_perm_b32 v41, v140, v136, s64
    v_perm_b32 v42, v148, v144, s64
    v_perm_b32 v43, v156, v152, s64
    v_perm_b32 v44, v132, v128, s65
    v_perm_b32 v45, v140, v136, s65
    v_perm_b32 v46, v148, v144, s65
    v_perm_b32 v47, v156, v152, s65
    v_mfma_f32_16x16x32_bf16 v[64:67], v[40:43], v[20:23], v[64:67]
    s_nop 0
    v_mfma_f32_16x16x32_bf16 v[68:71], v[44:47], v[20:23], v[68:71]
    v_perm_b32 v48, v133, v129, s64
    v_perm_b32 v49, v141, v137, s64
    v_perm_b32 v50, v149, v145, s64
    v_perm_b32 v51, v157, v153, s64
    v_perm_b32 v52, v133, v129, s65
    v_perm_b32 v53, v141, v137, s65
    v_perm_b32 v54, v149, v145, s65
    v_perm_b32 v55, v157, v153, s65
    v_mfma_f32_16x16x32_bf16 v[72:75], v[48:51], v[20:23], v[72:75]
    s_nop 0
    v_mfma_f32_16x16x32_bf16 v[76:79], v[52:55], v[20:23], v[76:79]
    v_perm_b32 v40, v134, v130, s64
    v_perm_b32 v41, v142, v138, s64
    v_perm_b32 v42, v150, v146, s64
    v_perm_b32 v43, v158, v154, s64
    v_perm_b32 v44, v134, v130, s65
    v_perm_b32 v45, v142, v138, s65
    v_perm_b32 v46, v150, v146, s65
    v_perm_b32 v47, v158, v154, s65
    v_mfma_f32_16x16x32_bf16 v[80:83], v[40:43], v[20:23], v[80:83]
    s_nop 0
    v_mfma_f32_16x16x32_bf16 v[84:87], v[44:47], v[20:23], v[84:87]
    v_perm_b32 v48, v135, v131, s64
    v_perm_b32 v49, v143, v139, s64
    v_perm_b32 v50, v151, v147, s64
    v_perm_b32 v51, v159, v155, s64
    v_perm_b32 v52, v135, v131, s65
    v_perm_b32 v53, v143, v139, s65
    v_perm_b32 v54, v151, v147, s65
    v_perm_b32 v55, v159, v155, s65
    v_mfma_f32_16x16x32_bf16 v[88:91], v[48:51], v[20:23], v[88:91]
    s_nop 0
    v_mfma_f32_16x16x32_bf16 v[92:95], v[52:55], v[20:23], v[92:95]
    s_waitcnt vmcnt(11)
    buffer_load_dwordx4 v[112:115], v6, s[60:63], s11 offen offset:0 nt
    s_waitcnt vmcnt(11)
    buffer_load_dwordx4 v[116:119], v6, s[60:63], s11 offen offset:1024 nt
    s_waitcnt vmcnt(11)
    buffer_load_dwordx4 v[120:123], v6, s[60:63], s11 offen offset:2048 nt
    s_waitcnt vmcnt(11)
    buffer_load_dwordx4 v[124:127], v6, s[60:63], s11 offen offset:3072 nt
    s_waitcnt vmcnt(8)
    v_perm_b32 v40, v164, v160, s64
    v_perm_b32 v41, v172, v168, s64
    v_perm_b32 v42, v180, v176, s64
    v_perm_b32 v43, v188, v184, s64
    v_perm_b32 v44, v164, v160, s65
    v_perm_b32 v45, v172, v168, s65
    v_perm_b32 v46, v180, v176, s65
    v_perm_b32 v47, v188, v184, s65
    v_mfma_f32_16x16x32_bf16 v[64:67], v[40:43], v[24:27], v[64:67]
    s_nop 0
    v_mfma_f32_16x16x32_bf16 v[68:71], v[44:47], v[24:27], v[68:71]
    v_perm_b32 v48, v165, v161, s64
    v_perm_b32 v49, v173, v169, s64
    v_perm_b32 v50, v181, v177, s64
    v_perm_b32 v51, v189, v185, s64
    v_perm_b32 v52, v165, v161, s65
    v_perm_b32 v53, v173, v169, s65
    v_perm_b32 v54, v181, v177, s65
    v_perm_b32 v55, v189, v185, s65
    v_mfma_f32_16x16x32_bf16 v[72:75], v[48:51], v[24:27], v[72:75]
    s_nop 0
    v_mfma_f32_16x16x32_bf16 v[76:79], v[52:55], v[24:27], v[76:79]
    v_perm_b32 v40, v166, v162, s64
    v_perm_b32 v41, v174, v170, s64
    v_perm_b32 v42, v182, v178, s64
    v_perm_b32 v43, v190, v186, s64
    v_perm_b32 v44, v166, v162, s65
    v_perm_b32 v45, v174, v170, s65
    v_perm_b32 v46, v182, v178, s65
    v_perm_b32 v47, v190, v186, s65
    v_mfma_f32_16x16x32_bf16 v[80:83], v[40:43], v[24:27], v[80:83]
    s_nop 0
    v_mfma_f32_16x16x32_bf16 v[84:87], v[44:47], v[24:27], v[84:87]
    v_perm_b32 v48, v167, v163, s64
    v_perm_b32 v49, v175, v171, s64
    v_perm_b32 v50, v183, v179, s64
    v_perm_b32 v51, v191, v187, s64
    v_perm_b32 v52, v167, v163, s65
    v_perm_b32 v53, v175, v171, s65
    v_perm_b32 v54, v183, v179, s65
    v_perm_b32 v55, v191, v187, s65
    v_mfma_f32_16x16x32_bf16 v[88:91], v[48:51], v[24:27], v[88:91]
    s_nop 0
    v_mfma_f32_16x16x32_bf16 v[92:95], v[52:55], v[24:27], v[92:95]
    s_mov_b32 s67, 4194304
L_ml_45:
    ds_read_b128 v[40:43], v63 offset:0
    ds_read_b128 v[44:47], v63 offset:16
    ds_read_b128 v[48:51], v63 offset:32
    ds_read_b128 v[52:55], v63 offset:48
    s_waitcnt lgkmcnt(0)
    v_max_u32 v56, v41, v43
    v_max3_u32 v56, v56, v45, v47
    v_max3_u32 v56, v56, v49, v51
    v_max3_u32 v56, v56, v53, v55
    v_cmp_eq_u32 vcc, -1, v56
    s_cbranch_vccz L_mlok_46
    s_sleep 2
    s_sub_u32 s67, s67, 1
    s_cbranch_scc0 L_ml_45
L_mlok_46:
    v_max_f32 v58, v40, v42
    v_max3_f32 v58, v58, v44, v46
    v_max3_f32 v58, v58, v48, v50
    v_max3_f32 v58, v58, v52, v54
    v_sub_f32 v10, v5, v58
    v_mul_f32 v10, 0x3fb8aa3b, v10
    v_exp_f32 v10, v10
    v_mov_b32 v11, 0xffffff00
    s_mul_i32 s14, s47, 6
    s_add_u32 s14, s14, s68
    s_sub_u32 s14, s14, 14
    s_mul_hi_u32 s15, s14, 613566757
    s_add_u32 s14, s14, s15
    s_sub_u32 s14, s14, 4
    s_lshl_b32 s15, s47, 3
    s_add_u32 s15, s15, 3
    s_min_u32 s15, s15, 55
    s_cmp_eq_u32 s68, 17
    s_cselect_b32 s14, s15, s14
    s_lshl_b32 s69, s3, 8
    v_bfe_u32 v7, v0, 4, 2
    v_lshlrev_b32 v7, 11, v7
    v_and_b32 v56, 15, v0
    v_lshl_add_u32 v7, v56, 4, v7
    v_add_u32 v7, s69, v7
    s_waitcnt vmcnt(0)
    v_perm_b32 v40, v100, v96, s64
    v_perm_b32 v41, v108, v104, s64
    v_perm_b32 v42, v116, v112, s64
    v_perm_b32 v43, v124, v120, s64
    v_perm_b32 v44, v100, v96, s65
    v_perm_b32 v45, v108, v104, s65
    v_perm_b32 v46, v116, v112, s65
    v_perm_b32 v47, v124, v120, s65
    v_mfma_f32_16x16x32_bf16 v[64:67], v[40:43], v[28:31], v[64:67]
    s_nop 0
    v_mfma_f32_16x16x32_bf16 v[68:71], v[44:47], v[28:31], v[68:71]
    v_perm_b32 v48, v101, v97, s64
    v_perm_b32 v49, v109, v105, s64
    v_perm_b32 v50, v117, v113, s64
    v_perm_b32 v51, v125, v121, s64
    v_perm_b32 v52, v101, v97, s65
    v_perm_b32 v53, v109, v105, s65
    v_perm_b32 v54, v117, v113, s65
    v_perm_b32 v55, v125, v121, s65
    v_mfma_f32_16x16x32_bf16 v[72:75], v[48:51], v[28:31], v[72:75]
    s_nop 0
    v_mfma_f32_16x16x32_bf16 v[76:79], v[52:55], v[28:31], v[76:79]
    v_perm_b32 v40, v102, v98, s64
    v_perm_b32 v41, v110, v106, s64
    v_perm_b32 v42, v118, v114, s64
    v_perm_b32 v43, v126, v122, s64
    v_perm_b32 v44, v102, v98, s65
    v_perm_b32 v45, v110, v106, s65
    v_perm_b32 v46, v118, v114, s65
    v_perm_b32 v47, v126, v122, s65
    v_mfma_f32_16x16x32_bf16 v[80:83], v[40:43], v[28:31], v[80:83]
    s_nop 0
    v_mfma_f32_16x16x32_bf16 v[84:87], v[44:47], v[28:31], v[84:87]
    v_perm_b32 v48, v103, v99, s64
    v_perm_b32 v49, v111, v107, s64
    v_perm_b32 v50, v119, v115, s64
    v_perm_b32 v51, v127, v123, s64
    v_perm_b32 v52, v103, v99, s65
    v_perm_b32 v53, v111, v107, s65
    v_perm_b32 v54, v119, v115, s65
    v_perm_b32 v55, v127, v123, s65
    v_mfma_f32_16x16x32_bf16 v[88:91], v[48:51], v[28:31], v[88:91]
    s_nop 0
    v_mfma_f32_16x16x32_bf16 v[92:95], v[52:55], v[28:31], v[92:95]
    s_mov_b32 exec_lo, 0xff00ff
    s_mov_b32 exec_hi, 0xff00ff
    v_pk_mul_f32 v[64:65], v[64:65], v[10:11] op_sel_hi:[1,0]
    v_pk_mul_f32 v[66:67], v[66:67], v[10:11] op_sel_hi:[1,0]
    ds_write_b128 v1, v[64:67] offset:0
    v_pk_mul_f32 v[68:69], v[68:69], v[10:11] op_sel_hi:[1,0]
    v_pk_mul_f32 v[70:71], v[70:71], v[10:11] op_sel_hi:[1,0]
    ds_write_b128 v1, v[68:71] offset:528
    v_pk_mul_f32 v[72:73], v[72:73], v[10:11] op_sel_hi:[1,0]
    v_pk_mul_f32 v[74:75], v[74:75], v[10:11] op_sel_hi:[1,0]
    ds_write_b128 v1, v[72:75] offset:1056
    v_pk_mul_f32 v[76:77], v[76:77], v[10:11] op_sel_hi:[1,0]
    v_pk_mul_f32 v[78:79], v[78:79], v[10:11] op_sel_hi:[1,0]
    ds_write_b128 v1, v[76:79] offset:1584
    v_pk_mul_f32 v[80:81], v[80:81], v[10:11] op_sel_hi:[1,0]
    v_pk_mul_f32 v[82:83], v[82:83], v[10:11] op_sel_hi:[1,0]
    ds_write_b128 v1, v[80:83] offset:2112
    v_pk_mul_f32 v[84:85], v[84:85], v[10:11] op_sel_hi:[1,0]
    v_pk_mul_f32 v[86:87], v[86:87], v[10:11] op_sel_hi:[1,0]
    ds_write_b128 v1, v[84:87] offset:2640
    v_pk_mul_f32 v[88:89], v[88:89], v[10:11] op_sel_hi:[1,0]
    v_pk_mul_f32 v[90:91], v[90:91], v[10:11] op_sel_hi:[1,0]
    ds_write_b128 v1, v[88:91] offset:3168
    v_pk_mul_f32 v[92:93], v[92:93], v[10:11] op_sel_hi:[1,0]
    v_pk_mul_f32 v[94:95], v[94:95], v[10:11] op_sel_hi:[1,0]
    ds_write_b128 v1, v[92:95] offset:3696
    s_mov_b64 exec, -1
    s_waitcnt lgkmcnt(0)
    s_barrier
    ds_read_b64 v[40:41], v3 offset:0
    ds_read_b64 v[42:43], v3 offset:16384
    ds_read_b64 v[44:45], v3 offset:32768
    ds_read_b64 v[46:47], v3 offset:49152
    ds_read_b64 v[48:49], v4 offset:0
    ds_read_b64 v[50:51], v4 offset:16384
    ds_read_b64 v[52:53], v4 offset:32768
    ds_read_b64 v[54:55], v4 offset:49152
    s_waitcnt lgkmcnt(4)
    v_pk_add_f32 v[40:41], v[40:41], v[44:45]
    v_pk_add_f32 v[42:43], v[42:43], v[46:47]
    s_waitcnt lgkmcnt(0)
    v_pk_add_f32 v[48:49], v[48:49], v[52:53]
    v_pk_add_f32 v[50:51], v[50:51], v[54:55]
    v_pk_add_f32 v[40:41], v[40:41], v[48:49]
    v_pk_add_f32 v[42:43], v[42:43], v[50:51]
    v_pk_add_f32 v[40:41], v[40:41], v[42:43]
    v_and_or_b32 v40, v40, v11, s26
    v_and_or_b32 v41, v41, v11, s26
    buffer_store_dwordx2 v[40:41], v62, s[48:51], s96 offen sc1
    s_cmp_ge_u32 s68, 17
    s_cbranch_scc1 L_mlp
    s_sub_u32 s14, s68, 1
    s_lshl_b32 s14, s14, 3
    s_add_u32 s14, s14, s47
    s_cmp_lt_u32 s14, 32
    s_cbranch_scc1 L_late
    s_endpgm
L_late:
    s_lshl_b32 s4, s3, 6
    v_add_u32 v7, s4, v0
    v_bfe_u32 v8, v7, 3, 6
    v_mul_u32_u24 v8, 98304, v8
    v_and_b32 v31, 7, v7
    v_lshl_add_u32 v8, v31, 4, v8
    s_add_u32 s14, s14, 96
    v_bfe_u32 v30, v7, 3, 6
    v_lshlrev_b32 v30, 6, v30
    v_and_b32 v24, 3, v7
    v_lshl_add_u32 v30, v24, 4, v30
    v_bfe_u32 v24, v7, 2, 1
    v_lshl_add_u32 v30, v24, 3, v30
    s_mov_b32 s60, s36
    s_mov_b32 s61, s37
    s_mov_b32 s62, 0x1000
    s_mov_b32 s63, 0x20000
    s_barrier
    buffer_load_dwordx2 v[12:13], v30, s[60:63], 0 offen
    s_and_b32 s15, s14, 1
    s_lshr_b32 s6, s14, 1
    s_lshl_b32 s6, s6, 7
    s_mul_i32 s13, s15, 6291456
    s_add_u32 s13, s13, s6
    s_add_u32 s13, s13, 4096
    s_mov_b32 s56, s38
    s_mov_b32 s57, s39
    s_mov_b32 s58, 0xc00000
    s_mov_b32 s59, 0x20000
    s_add_u32 s4, s13, 0
    buffer_load_dwordx4 v[64:67], v8, s[56:59], s4 offen nt
    s_add_u32 s4, s4, 12288
    buffer_load_dwordx4 v[68:71], v8, s[56:59], s4 offen nt
    s_add_u32 s4, s4, 12288
    buffer_load_dwordx4 v[72:75], v8, s[56:59], s4 offen nt
    s_add_u32 s4, s4, 12288
    buffer_load_dwordx4 v[76:79], v8, s[56:59], s4 offen nt
    s_add_u32 s4, s4, 12288
    buffer_load_dwordx4 v[80:83], v8, s[56:59], s4 offen nt
    s_add_u32 s4, s4, 12288
    buffer_load_dwordx4 v[84:87], v8, s[56:59], s4 offen nt
    s_add_u32 s4, s4, 12288
    buffer_load_dwordx4 v[88:91], v8, s[56:59], s4 offen nt
    s_add_u32 s4, s4, 12288
    buffer_load_dwordx4 v[92:95], v8, s[56:59], s4 offen nt
    s_lshl_b32 s4, s3, 6
    v_add_u32 v7, s4, v0
    v_bfe_u32 v30, v7, 3, 6
    v_lshlrev_b32 v30, 6, v30
    v_and_b32 v24, 3, v7
    v_lshl_add_u32 v30, v24, 4, v30
    v_bfe_u32 v24, v7, 2, 1
    v_lshl_add_u32 v30, v24, 3, v30
    v_bfe_u32 v1, v30, 11, 1
    v_mul_u32_u24 v1, 2176, v1
    v_and_b32 v24, 2047, v30
    v_add_u32 v1, v1, v24
    v_and_b32 v2, 1, v7
    v_mul_u32_u24 v2, 2176, v2
    v_bfe_u32 v24, v7, 6, 3
    v_lshl_add_u32 v2, v24, 7, v2
    v_bfe_u32 v24, v7, 4, 2
    v_lshl_add_u32 v2, v24, 5, v2
    v_bfe_u32 v24, v7, 1, 1
    v_lshl_add_u32 v2, v24, 4, v2
    v_bfe_u32 v3, v7, 6, 3
    v_mul_u32_u24 v3, 1088, v3
    v_bfe_u32 v24, v7, 1, 1
    v_mul_u32_u24 v24, 544, v24
    v_add_u32 v3, v3, v24
    v_and_b32 v24, 1, v7
    v_lshl_add_u32 v3, v24, 8, v3
    v_bfe_u32 v24, v7, 2, 2
    v_lshl_add_u32 v3, v24, 5, v3
    v_bfe_u32 v24, v7, 4, 1
    v_lshl_add_u32 v3, v24, 4, v3
    v_add_u32 v3, 12800, v3
    v_and_b32 v4, 3, v7
    v_mul_u32_u24 v4, 544, v4
    v_bfe_u32 v24, v7, 2, 7
    v_lshl_add_u32 v4, v24, 2, v4
    v_add_u32 v4, 12800, v4
    v_bfe_u32 v5, v7, 8, 1
    v_lshlrev_b32 v5, 7, v5
    v_bfe_u32 v24, v7, 2, 3
    v_lshl_add_u32 v5, v24, 4, v5
    v_bfe_u32 v24, v7, 5, 2
    v_lshl_add_u32 v5, v24, 2, v5
    v_bfe_u32 v24, v7, 7, 1
    v_lshl_add_u32 v5, v24, 1, v5
    v_add_u32 v5, 21504, v5
    s_waitcnt vmcnt(8)
    v_lshlrev_b32 v32, 16, v12
    v_and_b32 v33, s66, v12
    v_lshlrev_b32 v34, 16, v13
    v_and_b32 v35, s66, v13
    v_mul_f32 v24, 0xbfb8aa3b, v32
    v_mul_f32 v25, 0xbfb8aa3b, v33
    v_mul_f32 v26, 0xbfb8aa3b, v34
    v_mul_f32 v27, 0xbfb8aa3b, v35
    v_exp_f32 v24, v24
    v_exp_f32 v25, v25
    v_exp_f32 v26, v26
    v_exp_f32 v27, v27
    v_add_f32 v24, 1.0, v24
    v_add_f32 v25, 1.0, v25
    v_add_f32 v26, 1.0, v26
    v_add_f32 v27, 1.0, v27
    v_rcp_f32 v24, v24
    v_rcp_f32 v25, v25
    v_rcp_f32 v26, v26
    v_rcp_f32 v27, v27
    v_mul_f32 v24, v24, v32
    v_mul_f32 v25, v25, v33
    v_mul_f32 v26, v26, v34
    v_mul_f32 v27, v27, v35
    v_cvt_pk_bf16_f32 v28, v24, v25
    v_cvt_pk_bf16_f32 v29, v26, v27
    ds_write_b64 v1, v[28:29] offset:4096
    s_waitcnt lgkmcnt(0)
    s_barrier
L_late2:
    s_lshl_b32 s12, s15, 15
    s_lshl_b32 s5, s6, 1
    s_add_u32 s12, s12, s5
    s_add_u32 s12, s12, 262144
    s_lshl_b32 s4, s15, 10
    v_add_u32 v9, s4, v2
    v_mov_b32 v10, 0xffffff00
    s_waitcnt vmcnt(0)
    v_perm_b32 v24, v68, v64, s64
    v_perm_b32 v68, v68, v64, s65
    v_mov_b32 v64, v24
    v_perm_b32 v24, v77, v73, s64
    v_perm_b32 v77, v77, v73, s65
    v_mov_b32 v73, v24
    v_perm_b32 v24, v86, v82, s64
    v_perm_b32 v86, v86, v82, s65
    v_mov_b32 v82, v24
    v_perm_b32 v24, v95, v91, s64
    v_perm_b32 v95, v95, v91, s65
    v_mov_b32 v91, v24
    v_perm_b32 v24, v69, v65, s64
    v_perm_b32 v25, v69, v65, s65
    v_perm_b32 v65, v76, v72, s64
    v_perm_b32 v69, v76, v72, s65
    v_mov_b32 v72, v24
    v_mov_b32 v76, v25
    v_perm_b32 v24, v70, v66, s64
    v_perm_b32 v25, v70, v66, s65
    v_perm_b32 v66, v84, v80, s64
    v_perm_b32 v70, v84, v80, s65
    v_mov_b32 v80, v24
    v_mov_b32 v84, v25
    v_perm_b32 v24, v71, v67, s64
    v_perm_b32 v25, v71, v67, s65
    v_perm_b32 v67, v92, v88, s64
    v_perm_b32 v71, v92, v88, s65
    v_mov_b32 v88, v24
    v_mov_b32 v92, v25
    v_perm_b32 v24, v78, v74, s64
    v_perm_b32 v25, v78, v74, s65
    v_perm_b32 v74, v85, v81, s64
    v_perm_b32 v78, v85, v81, s65
    v_mov_b32 v81, v24
    v_mov_b32 v85, v25
    v_perm_b32 v24, v79, v75, s64
    v_perm_b32 v25, v79, v75, s65
    v_perm_b32 v75, v93, v89, s64
    v_perm_b32 v79, v93, v89, s65
    v_mov_b32 v89, v24
    v_mov_b32 v93, v25
    v_perm_b32 v24, v87, v83, s64
    v_perm_b32 v25, v87, v83, s65
    v_perm_b32 v83, v94, v90, s64
    v_perm_b32 v87, v94, v90, s65
    v_mov_b32 v90, v24
    v_mov_b32 v94, v25
    ds_read_b128 v[24:27], v9 offset:4096
    s_waitcnt lgkmcnt(0)
    v_mfma_f32_16x16x32_bf16 v[32:35], v[64:67], v[24:27], 0
    v_mfma_f32_16x16x32_bf16 v[36:39], v[68:71], v[24:27], 0
    v_mfma_f32_16x16x32_bf16 v[40:43], v[72:75], v[24:27], 0
    v_mfma_f32_16x16x32_bf16 v[44:47], v[76:79], v[24:27], 0
    v_mfma_f32_16x16x32_bf16 v[48:51], v[80:83], v[24:27], 0
    v_mfma_f32_16x16x32_bf16 v[52:55], v[84:87], v[24:27], 0
    v_mfma_f32_16x16x32_bf16 v[56:59], v[88:91], v[24:27], 0
    v_mfma_f32_16x16x32_bf16 v[60:63], v[92:95], v[24:27], 0
    s_mov_b32 exec_lo, 0xf000f0
    s_mov_b32 exec_hi, 0xf000f0
    s_nop 1
    v_mov_b64 v[32:33], v[40:41]
    v_mov_b64 v[34:35], v[42:43]
    v_mov_b64 v[36:37], v[44:45]
    v_mov_b64 v[38:39], v[46:47]
    s_mov_b32 exec_lo, 0xf000f00
    s_mov_b32 exec_hi, 0xf000f00
    v_mov_b64 v[32:33], v[48:49]
    v_mov_b64 v[34:35], v[50:51]
    v_mov_b64 v[36:37], v[52:53]
    v_mov_b64 v[38:39], v[54:55]
    s_mov_b32 exec_lo, 0xf000f000
    s_mov_b32 exec_hi, 0xf000f000
    s_nop 1
    v_mov_b64 v[32:33], v[56:57]
    v_mov_b64 v[34:35], v[58:59]
    v_mov_b64 v[36:37], v[60:61]
    v_mov_b64 v[38:39], v[62:63]
    s_mov_b32 exec_lo, 0x33333333
    s_mov_b32 exec_hi, 0xcccccccc
    ds_write_b128 v3, v[32:35]
    ds_write_b128 v3, v[36:39] offset:128
    s_mov_b64 exec, -1
    s_waitcnt lgkmcnt(0)
    s_barrier
    ds_read_b32 v24, v4 offset:0
    ds_read_b32 v25, v4 offset:2176
    ds_read_b32 v26, v4 offset:4352
    ds_read_b32 v27, v4 offset:6528
    s_waitcnt lgkmcnt(2)
    v_add_f32 v24, v24, v25
    s_waitcnt lgkmcnt(0)
    v_add_f32 v26, v26, v27
    v_add_f32 v24, v24, v26
    s_nop 1
    v_add_f32_dpp v24, v24, v24 quad_perm:[1,0,3,2] row_mask:0xf bank_mask:0xf
    s_nop 1
    v_add_f32_dpp v24, v24, v24 quad_perm:[2,3,0,1] row_mask:0xf bank_mask:0xf
    v_and_or_b32 v24, v24, v10, s26
    v_subrev_u32 v25, 21504, v5
    v_lshlrev_b32 v25, 1, v25
    ds_write_b32 v25, v24 offset:21760
    s_waitcnt lgkmcnt(0)
    s_barrier
    s_cmp_lg_u32 s3, 0
    s_cbranch_scc1 L_skip_47
    v_lshlrev_b32 v28, 4, v0
    ds_read_b128 v[24:27], v28 offset:21760
    v_bfe_u32 v29, v0, 4, 1
    v_lshlrev_b32 v29, 14, v29
    v_and_b32 v30, 15, v0
    v_lshl_add_u32 v29, v30, 4, v29
    s_waitcnt lgkmcnt(0)
    s_mov_b32 exec_hi, 0
    buffer_store_dwordx4 v[24:27], v29, s[48:51], s12 offen sc1
    s_mov_b64 exec, -1
    s_nop 0
L_skip_47:
    s_endpgm
L_mlp:
    s_mov_b32 s56, s32
    s_mov_b32 s57, s33
    s_mov_b32 s58, 0x700000
    s_mov_b32 s59, 0x20000
    s_lshl_b32 s5, s14, 17
    s_add_u32 s4, s5, 0
    buffer_load_dwordx4 v[128:131], v7, s[56:59], s4 offen nt
    s_add_u32 s4, s5, 8192
    buffer_load_dwordx4 v[136:139], v7, s[56:59], s4 offen nt
    s_add_u32 s4, s5, 16384
    buffer_load_dwordx4 v[144:147], v7, s[56:59], s4 offen nt
    s_lshl_b32 s4, s3, 6
    v_add_u32 v7, s4, v0
    s_lshl_b32 s7, s14, 7
    v_bfe_u32 v16, v7, 8, 1
    v_lshlrev_b32 v16, 14, v16
    v_and_b32 v24, 255, v7
    v_lshl_add_u32 v16, v24, 4, v16
    v_add_u32 v16, 266240, v16
    v_add_u32 v22, 4096, v16
    s_mov_b32 s8, 32768
    s_mov_b32 s9, 65536
    s_mov_b32 s10, 98304
    s_mov_b32 s60, s30
    s_mov_b32 s61, s31
    s_mov_b32 s62, 0x1c00
    s_mov_b32 s63, 0x20000
    v_bfe_u32 v28, v7, 2, 6
    v_lshlrev_b32 v28, 1, v28
    v_add_u32 v28, s7, v28
    v_bfe_u32 v29, v7, 4, 2
    v_lshlrev_b32 v29, 11, v29
    v_bfe_u32 v31, v7, 6, 3
    v_lshl_add_u32 v29, v31, 8, v29
    v_and_b32 v31, 15, v7
    v_lshl_add_u32 v29, v31, 4, v29
    s_barrier
    buffer_load_ushort v17, v28, s[60:63], 0 offen
    s_getpc_b64 s[98:99]
L_pc_48:
    s_add_u32 s98, s98, L_mlp_tail-L_pc_48
    s_addc_u32 s99, s99, 0
    s_and_b32 s98, s98, 0xffffff80
    s_lshl_b32 s97, s3, 10
    v_lshl_add_u32 v28, v0, 4, s97
    global_load_dwordx4 v[40:43], v28, s[98:99]
    s_mov_b32 s56, s32
    s_mov_b32 s57, s33
    s_mov_b32 s58, 0x700000
    s_mov_b32 s59, 0x20000
    s_lshl_b32 s5, s14, 17
    s_add_u32 s4, s5, 24576
    buffer_load_dwordx4 v[152:155], v29, s[56:59], s4 offen nt
    s_add_u32 s4, s5, 32768
    buffer_load_dwordx4 v[160:163], v29, s[56:59], s4 offen nt
    s_add_u32 s4, s5, 40960
    buffer_load_dwordx4 v[168:171], v29, s[56:59], s4 offen nt
    s_add_u32 s4, s5, 49152
    buffer_load_dwordx4 v[176:179], v29, s[56:59], s4 offen nt
    s_add_u32 s4, s5, 57344
    buffer_load_dwordx4 v[184:187], v29, s[56:59], s4 offen nt
    s_add_u32 s4, s5, 65536
    buffer_load_dwordx4 v[132:135], v29, s[56:59], s4 offen nt
    s_add_u32 s4, s5, 73728
    buffer_load_dwordx4 v[140:143], v29, s[56:59], s4 offen nt
    s_add_u32 s4, s5, 81920
    buffer_load_dwordx4 v[148:151], v29, s[56:59], s4 offen nt
    s_add_u32 s4, s5, 90112
    buffer_load_dwordx4 v[156:159], v29, s[56:59], s4 offen nt
    s_add_u32 s4, s5, 98304
    buffer_load_dwordx4 v[164:167], v29, s[56:59], s4 offen nt
    s_add_u32 s4, s5, 106496
    buffer_load_dwordx4 v[172:175], v29, s[56:59], s4 offen nt
    s_add_u32 s4, s5, 114688
    buffer_load_dwordx4 v[180:183], v29, s[56:59], s4 offen nt
    s_add_u32 s4, s5, 122880
    buffer_load_dwordx4 v[188:191], v29, s[56:59], s4 offen nt
    v_bfe_u32 v1, v7, 8, 1
    v_mul_u32_u24 v1, 2176, v1
    v_bfe_u32 v24, v7, 3, 5
    v_lshl_add_u32 v1, v24, 6, v1
    v_bfe_u32 v24, v7, 1, 1
    v_lshl_add_u32 v1, v24, 5, v1
    v_bfe_u32 v24, v7, 2, 1
    v_lshl_add_u32 v1, v24, 3, v1
    v_and_b32 v24, 1, v7
    v_lshl_add_u32 v1, v24, 2, v1
    v_add_u32 v1, 8448, v1
    v_bfe_u32 v2, v7, 1, 1
    v_mul_u32_u24 v2, 2176, v2
    v_bfe_u32 v24, v7, 5, 1
    v_lshl_add_u32 v2, v24, 10, v2
    v_bfe_u32 v24, v7, 6, 3
    v_lshl_add_u32 v2, v24, 7, v2
    v_bfe_u32 v24, v7, 4, 1
    v_lshl_add_u32 v2, v24, 6, v2
    v_bfe_u32 v24, v7, 2, 1
    v_lshl_add_u32 v2, v24, 5, v2
    v_and_b32 v24, 1, v7
    v_lshl_add_u32 v2, v24, 4, v2
    v_add_u32 v2, 8448, v2
    v_bfe_u32 v3, v7, 6, 3
    v_mul_u32_u24 v3, 1088, v3
    v_bfe_u32 v24, v7, 4, 1
    v_mul_u32_u24 v24, 544, v24
    v_add_u32 v3, v3, v24
    v_and_b32 v24, 7, v7
    v_lshl_add_u32 v3, v24, 5, v3
    v_bfe_u32 v24, v7, 5, 1
    v_lshl_add_u32 v3, v24, 4, v3
    v_add_u32 v3, 12800, v3
    v_and_b32 v4, 3, v7
    v_mul_u32_u24 v4, 544, v4
    v_bfe_u32 v24, v7, 2, 7
    v_lshl_add_u32 v4, v24, 2, v4
    v_add_u32 v4, 12800, v4
    v_bfe_u32 v5, v7, 8, 1
    v_lshlrev_b32 v5, 7, v5
    v_bfe_u32 v24, v7, 7, 1
    v_lshl_add_u32 v5, v24, 6, v5
    v_bfe_u32 v24, v7, 3, 1
    v_lshl_add_u32 v5, v24, 5, v5
    v_bfe_u32 v24, v7, 5, 1
    v_lshl_add_u32 v5, v24, 4, v5
    v_bfe_u32 v24, v7, 2, 1
    v_lshl_add_u32 v5, v24, 3, v5
    v_bfe_u32 v24, v7, 6, 1
    v_lshl_add_u32 v5, v24, 2, v5
    v_bfe_u32 v24, v7, 4, 1
    v_lshl_add_u32 v5, v24, 1, v5
    v_add_u32 v5, 21504, v5
    v_bfe_u32 v6, v7, 1, 1
    v_lshlrev_b32 v6, 7, v6
    v_bfe_u32 v24, v7, 4, 2
    v_lshl_add_u32 v6, v24, 5, v6
    v_and_b32 v24, 1, v7
    v_lshl_add_u32 v6, v24, 4, v6
    v_add_u32 v6, 21504, v6
    v_bfe_u32 v9, v7, 2, 6
    v_lshlrev_b32 v9, 7, v9
    v_bfe_u32 v24, v7, 8, 1
    v_lshl_add_u32 v9, v24, 6, v9
    v_and_b32 v24, 3, v7
    v_lshl_add_u32 v9, v24, 4, v9
    v_add_u32 v9, 393216, v9
    s_and_b32 s4, s2, 7
    s_lshl_b32 s4, s4, 13
    v_add_u32 v9, s4, v9
    v_bfe_u32 v8, v7, 6, 3
    v_mul_u32_u24 v8, 66560, v8
    v_bfe_u32 v24, v7, 2, 2
    v_mul_u32_u24 v24, 16640, v24
    v_add_u32 v8, v8, v24
    v_bfe_u32 v24, v7, 1, 1
    v_lshl_add_u32 v8, v24, 7, v8
    v_and_b32 v24, 1, v7
    v_lshl_add_u32 v8, v24, 6, v8
    v_bfe_u32 v24, v7, 4, 2
    v_lshl_add_u32 v8, v24, 4, v8
    s_lshl_b32 s13, s7, 1
    s_add_u32 s13, s13, 3145728
    s_lshl_b32 s4, s3, 3
    v_mov_b32 v10, s4
    s_and_b32 s4, s4, 32
    v_mov_b32 v11, s4
    s_lshl_b32 s4, s3, 14
    s_add_u32 s4, s4, 12288
    v_lshl_add_u32 v24, v0, 4, s4
    ds_read_b128 v[64:67], v24 offset:0
    ds_read_b128 v[68:71], v24 offset:1024
    ds_read_b128 v[80:83], v24 offset:2048
    ds_read_b128 v[84:87], v24 offset:3072
    v_and_b32 v23, 1, v0
    v_mul_u32_u24 v23, 0xaaaa, v23
    v_add_u32 v23, 0x4444, v23
    s_waitcnt lgkmcnt(0)
    s_waitcnt vmcnt(13)
    s_mov_b32 s67, 262144
    s_branch L_chk_51
L_poll_49:
    buffer_load_dwordx4 v[64:67], v16, s[48:51], 0 offen sc1
    buffer_load_dwordx4 v[68:71], v16, s[48:51], s8 offen sc1
    buffer_load_dwordx4 v[80:83], v22, s[48:51], 0 offen sc1
    buffer_load_dwordx4 v[84:87], v22, s[48:51], s8 offen sc1
    s_waitcnt vmcnt(0)
L_chk_51:
    v_xor_b32 v64, s26, v64
    v_xor_b32 v65, s26, v65
    v_xor_b32 v66, s26, v66
    v_xor_b32 v67, s26, v67
    v_xor_b32 v68, s26, v68
    v_xor_b32 v69, s26, v69
    v_xor_b32 v70, s26, v70
    v_xor_b32 v71, s26, v71
    v_xor_b32 v80, s26, v80
    v_xor_b32 v81, s26, v81
    v_xor_b32 v82, s26, v82
    v_xor_b32 v83, s26, v83
    v_xor_b32 v84, s26, v84
    v_xor_b32 v85, s26, v85
    v_xor_b32 v86, s26, v86
    v_xor_b32 v87, s26, v87
    v_or_b32 v24, v64, v65
    v_or3_b32 v24, v24, v66, v67
    v_or3_b32 v24, v24, v68, v69
    v_or3_b32 v24, v24, v70, v71
    v_or3_b32 v24, v24, v80, v81
    v_or3_b32 v24, v24, v82, v83
    v_or3_b32 v24, v24, v84, v85
    v_or3_b32 v24, v24, v86, v87
    v_and_b32 v24, 255, v24
    v_cmp_ne_u32 vcc, 0, v24
    s_cbranch_vccz L_ok_50
    s_sleep 2
    s_sub_u32 s67, s67, 1
    s_cbranch_scc0 L_poll_49
L_ok_50:
    v_pk_add_f32 v[18:19], v[64:65], v[68:69]
    v_pk_add_f32 v[20:21], v[66:67], v[70:71]
    v_pk_add_f32 v[12:13], v[80:81], v[84:85]
    v_pk_add_f32 v[14:15], v[82:83], v[86:87]
    v_cvt_pk_bf16_f32 v18, 0, v18
    v_cvt_pk_bf16_f32 v19, 0, v19
    v_cvt_pk_bf16_f32 v20, 0, v20
    v_cvt_pk_bf16_f32 v21, 0, v21
    v_cvt_pk_bf16_f32 v12, 0, v12
    v_cvt_pk_bf16_f32 v13, 0, v13
    v_cvt_pk_bf16_f32 v14, 0, v14
    v_cvt_pk_bf16_f32 v15, 0, v15
    v_add_f32 v12, 1.0, v12
    v_add_f32 v13, 1.0, v13
    v_add_f32 v14, 1.0, v14
    v_add_f32 v15, 1.0, v15
    v_cvt_pk_bf16_f32 v12, 0, v12
    v_cvt_pk_bf16_f32 v13, 0, v13
    v_cvt_pk_bf16_f32 v14, 0, v14
    v_cvt_pk_bf16_f32 v15, 0, v15
    v_lshlrev_b32 v17, 16, v17
    v_bfe_u32 v10, v7, 8, 1
    v_lshlrev_b32 v10, 7, v10
    v_bfe_u32 v24, v7, 4, 2
    v_lshl_add_u32 v10, v24, 4, v10
    v_bfe_u32 v24, v7, 6, 2
    v_lshl_add_u32 v10, v24, 2, v10
    v_bfe_u32 v11, v7, 8, 1
    v_lshlrev_b32 v11, 7, v11
    v_add_f32 v24, v12, v13
    v_mul_f32 v25, v12, v12
    v_mul_f32 v26, v12, v18
    v_add_f32 v27, v18, v19
    v_mul_f32 v28, v18, v18
    v_mov_b32 v29, 0
    v_fmac_f32 v25, v13, v13
    v_fmac_f32 v26, v13, v19
    v_fmac_f32 v28, v19, v19
    v_add_f32 v24, v24, v14
    v_add_f32 v27, v27, v20
    v_fmac_f32 v25, v14, v14
    v_fmac_f32 v26, v14, v20
    v_fmac_f32 v28, v20, v20
    v_add_f32 v24, v24, v15
    v_add_f32 v27, v27, v21
    v_fmac_f32 v25, v15, v15
    v_fmac_f32 v26, v15, v21
    v_fmac_f32 v28, v21, v21
    s_nop 0
    s_nop 0
    v_permlane32_swap_b32 v24, v25
    v_permlane32_swap_b32 v26, v27
    v_permlane32_swap_b32 v28, v29
    v_add_f32 v24, v24, v25
    v_add_f32 v26, v26, v27
    v_add_f32 v28, v28, v29
    v_mov_b32 v29, v28
    v_permlane16_swap_b32 v24, v26
    v_add_f32 v24, v24, v26
    v_permlane16_swap_b32 v28, v29
    v_add_f32 v28, v28, v29
    v_add_f32_dpp v24, v24, v24 row_ror:8 row_mask:0xf bank_mask:0xf
    s_nop 0
    v_add_f32_dpp v28, v28, v28 row_ror:8 row_mask:0xf bank_mask:0xf
    s_nop 0
    v_add_f32_dpp v24, v24, v24 row_ror:4 row_mask:0xf bank_mask:0xf
    v_add_f32_dpp v28, v28, v28 row_ror:4 row_mask:0xf bank_mask:0xf
    s_nop 0
    v_add_f32_dpp v24, v24, v24 row_ror:2 row_mask:0xf bank_mask:0xf
    v_add_f32_dpp v28, v28, v28 row_ror:2 row_mask:0xf bank_mask:0xf
    s_nop 0
    v_add_f32_dpp v24, v24, v24 row_ror:1 row_mask:0xf bank_mask:0xf
    v_add_f32_dpp v28, v28, v28 row_ror:1 row_mask:0xf bank_mask:0xf
    ds_write_b32 v10, v24 offset:23040
    ds_write_b32 v10, v28 offset:23104
    s_waitcnt lgkmcnt(0)
    s_barrier
    ds_read_b128 v[96:99], v11 offset:23040
    ds_read_b128 v[100:103], v11 offset:23056
    ds_read_b128 v[104:107], v11 offset:23072
    ds_read_b128 v[108:111], v11 offset:23088
    ds_read_b128 v[112:115], v11 offset:23104
    ds_read_b128 v[116:119], v11 offset:23136
    s_waitcnt lgkmcnt(5)
    v_pk_add_f32 v[96:97], v[96:97], v[98:99]
    s_waitcnt lgkmcnt(4)
    v_pk_add_f32 v[100:101], v[100:101], v[102:103]
    s_waitcnt lgkmcnt(3)
    v_pk_add_f32 v[104:105], v[104:105], v[106:107]
    s_waitcnt lgkmcnt(2)
    v_pk_add_f32 v[108:109], v[108:109], v[110:111]
    s_waitcnt lgkmcnt(1)
    v_pk_add_f32 v[112:113], v[112:113], v[114:115]
    s_waitcnt lgkmcnt(0)
    v_pk_add_f32 v[116:117], v[116:117], v[118:119]
    v_add_f32 v96, v96, v97
    v_add_f32 v97, v100, v101
    v_add_f32 v98, v104, v105
    v_add_f32 v99, v108, v109
    v_add_f32 v100, v112, v113
    v_add_f32 v101, v116, v117
    v_mul_f32 v96, 0x3a800000, v96
    v_mul_f32 v97, 0x3a800000, v97
    v_mul_f32 v98, 0x3a800000, v98
    v_mul_f32 v99, 0x3a800000, v99
    v_mul_f32 v100, 0x3a800000, v100
    v_mov_b64 v[64:65], 0
    v_mov_b64 v[66:67], 0
    v_mov_b64 v[68:69], 0
    v_mov_b64 v[70:71], 0
    v_mov_b64 v[72:73], 0
    v_mov_b64 v[74:75], 0
    v_mov_b64 v[76:77], 0
    v_mov_b64 v[78:79], 0
    v_mov_b64 v[80:81], 0
    v_mov_b64 v[82:83], 0
    v_mov_b64 v[84:85], 0
    v_mov_b64 v[86:87], 0
    v_mov_b64 v[88:89], 0
    v_mov_b64 v[90:91], 0
    v_mov_b64 v[92:93], 0
    v_mov_b64 v[94:95], 0
    s_waitcnt vmcnt(8)
    v_perm_b32 v24, v136, v128, s64
    v_perm_b32 v136, v136, v128, s65
    v_mov_b32 v128, v24
    v_perm_b32 v24, v153, v145, s64
    v_perm_b32 v153, v153, v145, s65
    v_mov_b32 v145, v24
    v_perm_b32 v24, v170, v162, s64
    v_perm_b32 v170, v170, v162, s65
    v_mov_b32 v162, v24
    v_perm_b32 v24, v187, v179, s64
    v_perm_b32 v187, v187, v179, s65
    v_mov_b32 v179, v24
    v_perm_b32 v24, v137, v129, s64
    v_perm_b32 v25, v137, v129, s65
    v_perm_b32 v129, v152, v144, s64
    v_perm_b32 v137, v152, v144, s65
    v_mov_b32 v144, v24
    v_mov_b32 v152, v25
    v_perm_b32 v24, v138, v130, s64
    v_perm_b32 v25, v138, v130, s65
    v_perm_b32 v130, v168, v160, s64
    v_perm_b32 v138, v168, v160, s65
    v_mov_b32 v160, v24
    v_mov_b32 v168, v25
    v_perm_b32 v24, v139, v131, s64
    v_perm_b32 v25, v139, v131, s65
    v_perm_b32 v131, v184, v176, s64
    v_perm_b32 v139, v184, v176, s65
    v_mov_b32 v176, v24
    v_mov_b32 v184, v25
    v_perm_b32 v24, v154, v146, s64
    v_perm_b32 v25, v154, v146, s65
    v_perm_b32 v146, v169, v161, s64
    v_perm_b32 v154, v169, v161, s65
    v_mov_b32 v161, v24
    v_mov_b32 v169, v25
    v_perm_b32 v24, v155, v147, s64
    v_perm_b32 v25, v155, v147, s65
    v_perm_b32 v147, v185, v177, s64
    v_perm_b32 v155, v185, v177, s65
    v_mov_b32 v177, v24
    v_mov_b32 v185, v25
    v_perm_b32 v24, v171, v163, s64
    v_perm_b32 v25, v171, v163, s65
    v_perm_b32 v163, v186, v178, s64
    v_perm_b32 v171, v186, v178, s65
    v_mov_b32 v178, v24
    v_mov_b32 v186, v25
    s_waitcnt vmcnt(0)
    buffer_load_dwordx4 v[32:35], v9, s[48:51], 0 offen sc1
    v_perm_b32 v24, v140, v132, s64
    v_perm_b32 v140, v140, v132, s65
    v_mov_b32 v132, v24
    v_perm_b32 v24, v157, v149, s64
    v_perm_b32 v157, v157, v149, s65
    v_mov_b32 v149, v24
    v_perm_b32 v24, v174, v166, s64
    v_perm_b32 v174, v174, v166, s65
    v_mov_b32 v166, v24
    v_perm_b32 v24, v191, v183, s64
    v_perm_b32 v191, v191, v183, s65
    v_mov_b32 v183, v24
    v_perm_b32 v24, v141, v133, s64
    v_perm_b32 v25, v141, v133, s65
    v_perm_b32 v133, v156, v148, s64
    v_perm_b32 v141, v156, v148, s65
    v_mov_b32 v148, v24
    v_mov_b32 v156, v25
    v_perm_b32 v24, v142, v134, s64
    v_perm_b32 v25, v142, v134, s65
    v_perm_b32 v134, v172, v164, s64
    v_perm_b32 v142, v172, v164, s65
    v_mov_b32 v164, v24
    v_mov_b32 v172, v25
    v_perm_b32 v24, v143, v135, s64
    v_perm_b32 v25, v143, v135, s65
    v_perm_b32 v135, v188, v180, s64
    v_perm_b32 v143, v188, v180, s65
    v_mov_b32 v180, v24
    v_mov_b32 v188, v25
    v_perm_b32 v24, v158, v150, s64
    v_perm_b32 v25, v158, v150, s65
    v_perm_b32 v150, v173, v165, s64
    v_perm_b32 v158, v173, v165, s65
    v_mov_b32 v165, v24
    v_mov_b32 v173, v25
    v_perm_b32 v24, v159, v151, s64
    v_perm_b32 v25, v159, v151, s65
    v_perm_b32 v151, v189, v181, s64
    v_perm_b32 v159, v189, v181, s65
    v_mov_b32 v181, v24
    v_mov_b32 v189, v25
    v_perm_b32 v24, v175, v167, s64
    v_perm_b32 v25, v175, v167, s65
    v_perm_b32 v167, v190, v182, s64
    v_perm_b32 v175, v190, v182, s65
    v_mov_b32 v182, v24
    v_mov_b32 v190, v25
L_mlp_tail:
    s_waitcnt vmcnt(0)
    s_mov_b32 s67, 262144
    s_branch L_chk_54
L_poll_52:
    buffer_load_dwordx4 v[32:35], v9, s[48:51], 0 offen sc1
    s_waitcnt vmcnt(0)
L_chk_54:
    v_bitop3_b32 v24, v32, v33, s27 bitop3:0x7e
    v_bitop3_b32 v24, v24, v34, s27 bitop3:0xf6
    v_bitop3_b32 v24, v24, v35, s27 bitop3:0xf6
    v_cmp_ne_u16 vcc, 0, v24
    s_cbranch_vccz L_ok_53
    s_sub_u32 s67, s67, 1
    s_cbranch_scc0 L_poll_52
L_ok_53:
    v_and_b32 v32, s66, v32
    v_and_b32 v33, s66, v33
    v_and_b32 v34, s66, v34
    v_and_b32 v35, s66, v35
    v_pk_mul_f32 v[36:37], v[32:33], v[12:13]
    v_pk_mul_f32 v[38:39], v[34:35], v[14:15]
    v_pk_add_f32 v[40:41], v[32:33], v[34:35]
    v_pk_mul_f32 v[42:43], v[32:33], v[32:33]
    v_pk_add_f32 v[44:45], v[36:37], v[38:39]
    v_pk_mul_f32 v[46:47], v[36:37], v[36:37]
    v_pk_mul_f32 v[48:49], v[36:37], v[12:13]
    v_pk_mul_f32 v[50:51], v[36:37], v[18:19]
    v_pk_fma_f32 v[42:43], v[34:35], v[34:35], v[42:43]
    v_pk_fma_f32 v[46:47], v[38:39], v[38:39], v[46:47]
    v_pk_fma_f32 v[48:49], v[38:39], v[14:15], v[48:49]
    v_pk_fma_f32 v[50:51], v[38:39], v[20:21], v[50:51]
    v_add_f32 v24, v40, v41
    v_add_f32 v25, v44, v45
    v_add_f32 v26, v42, v43
    v_add_f32 v27, v46, v47
    v_add_f32 v28, v48, v49
    v_add_f32 v29, v50, v51
    s_nop 0
    v_permlane32_swap_b32 v24, v25
    v_permlane32_swap_b32 v26, v27
    v_permlane32_swap_b32 v28, v29
    v_add_f32 v24, v24, v25
    v_add_f32 v26, v26, v27
    v_add_f32 v28, v28, v29
    v_mov_b32 v29, v28
    v_permlane16_swap_b32 v24, v26
    v_add_f32 v24, v24, v26
    v_permlane16_swap_b32 v28, v29
    v_add_f32 v28, v28, v29
    v_add_f32_dpp v24, v24, v24 row_ror:8 row_mask:0xf bank_mask:0xf
    s_nop 0
    v_add_f32_dpp v28, v28, v28 row_ror:8 row_mask:0xf bank_mask:0xf
    s_nop 0
    v_add_f32_dpp v24, v24, v24 row_ror:4 row_mask:0xf bank_mask:0xf
    v_add_f32_dpp v28, v28, v28 row_ror:4 row_mask:0xf bank_mask:0xf
    s_nop 0
    v_add_f32_dpp v24, v24, v24 row_ror:2 row_mask:0xf bank_mask:0xf
    v_add_f32_dpp v28, v28, v28 row_ror:2 row_mask:0xf bank_mask:0xf
    s_nop 0
    v_add_f32_dpp v24, v24, v24 row_ror:1 row_mask:0xf bank_mask:0xf
    v_add_f32_dpp v28, v28, v28 row_ror:1 row_mask:0xf bank_mask:0xf
    ds_write_b32 v10, v24 offset:22784
    ds_write_b32 v10, v28 offset:22848
    s_waitcnt lgkmcnt(0)
    s_barrier
    ds_read_b128 v[40:43], v11 offset:22784
    ds_read_b128 v[44:47], v11 offset:22800
    ds_read_b128 v[48:51], v11 offset:22816
    ds_read_b128 v[52:55], v11 offset:22832
    ds_read_b128 v[56:59], v11 offset:22848
    ds_read_b128 v[60:63], v11 offset:22880
    s_waitcnt lgkmcnt(4)
    v_add_f32 v40, v40, v41
    v_add_f32 v44, v44, v45
    v_add_f32 v42, v42, v43
    v_add_f32 v46, v46, v47
    v_add_f32 v40, v40, v42
    v_add_f32 v44, v44, v46
    v_mul_f32 v40, 0x3a800000, v40
    v_mul_f32 v44, 0x3a800000, v44
    s_waitcnt lgkmcnt(0)
    v_fma_f32 v25, -v40, v40, v44
    v_cvt_pk_bf16_f32 v24, 0, v40
    v_add_f32 v48, v48, v49
    v_max_f32 v25, 0, v25
    v_add_f32 v52, v52, v53
    v_add_f32 v56, v56, v57
    v_cvt_pk_bf16_f32 v25, 0, v25
    v_add_f32 v60, v60, v61
    v_add_f32 v50, v50, v51
    v_add_f32 v25, 0x3727c5ac, v25
    v_add_f32 v54, v54, v55
    v_add_f32 v58, v58, v59
    v_cvt_pk_bf16_f32 v25, 0, v25
    v_add_f32 v62, v62, v63
    v_add_f32 v48, v48, v50
    v_sqrt_f32 v25, v25
    v_add_f32 v52, v52, v54
    v_add_f32 v56, v56, v58
    v_add_f32 v60, v60, v62
    v_cvt_pk_bf16_f32 v25, 0, v25
    v_mul_f32 v48, 0x3a800000, v48
    v_mul_f32 v52, 0x3a800000, v52
    v_rcp_f32 v25, v25
    v_mul_f32 v56, 0x3a800000, v56
    v_mul_f32 v60, 0x3a800000, v60
    v_fma_f32 v26, -v24, v96, v48
    v_fma_f32 v27, -v24, v97, v60
    v_fma_f32 v28, v24, v98, -v56
    v_add_f32 v27, v27, v27
    v_sub_f32 v28, v28, v56
    v_fma_f32 v36, -v24, v12, v36
    v_fma_f32 v28, v24, v28, v52
    v_fma_f32 v29, v26, v25, v99
    v_fma_f32 v30, v28, v25, v27
    v_fma_f32 v37, -v24, v13, v37
    v_fma_f32 v30, v30, v25, v100
    v_fma_f32 v38, -v24, v14, v38
    v_fma_f32 v30, -v29, v29, v30
    v_fma_f32 v39, -v24, v15, v39
    v_max_f32 v30, 0, v30
    v_cvt_pk_bf16_f32 v26, 0, v29
    v_cvt_pk_bf16_f32 v30, 0, v30
    v_fma_f32 v36, v36, v25, v18
    v_add_f32 v30, 0x3727c5ac, v30
    v_fma_f32 v37, v37, v25, v19
    v_cvt_pk_bf16_f32 v30, 0, v30
    v_fma_f32 v38, v38, v25, v20
    v_sqrt_f32 v30, v30
    v_fma_f32 v39, v39, v25, v21
    v_sub_f32 v36, v36, v26
    v_cvt_pk_bf16_f32 v30, 0, v30
    v_sub_f32 v37, v37, v26
    v_rcp_f32 v30, v30
    v_sub_f32 v38, v38, v26
    v_sub_f32 v39, v39, v26
    v_mul_f32 v36, v36, v30
    v_mul_f32 v37, v37, v30
    v_mul_f32 v38, v38, v30
    v_mul_f32 v39, v39, v30
    v_cvt_pk_bf16_f32 v30, v36, v37
    v_cvt_pk_bf16_f32 v31, v38, v39
    ds_write2_b32 v1, v30, v31 offset1:4
    s_waitcnt lgkmcnt(0)
    s_barrier
    ds_read_b128 v[24:27], v2
    v_mov_b64 v[32:33], 0
    v_mov_b64 v[34:35], 0
    v_mov_b64 v[36:37], 0
    v_mov_b64 v[38:39], 0
    v_mov_b64 v[40:41], 0
    v_mov_b64 v[42:43], 0
    v_mov_b64 v[44:45], 0
    v_mov_b64 v[46:47], 0
    v_mov_b64 v[48:49], 0
    s_waitcnt lgkmcnt(0)
    v_smfmac_f32_16x16x64_bf16 v[64:67], v[24:27], v[192:199], v23
    v_mov_b64 v[50:51], 0
    v_mov_b64 v[52:53], 0
    v_smfmac_f32_16x16x64_bf16 v[68:71], v[24:27], v[200:207], v23
    v_mov_b64 v[54:55], 0
    v_mov_b64 v[56:57], 0
    v_smfmac_f32_16x16x64_bf16 v[72:75], v[24:27], v[208:215], v23
    v_mov_b64 v[58:59], 0
    v_mov_b64 v[60:61], 0
    v_smfmac_f32_16x16x64_bf16 v[76:79], v[24:27], v[216:223], v23
    v_add_f32_dpp v104, v64, v65 quad_perm:[0,1,2,3] row_mask:0x3 bank_mask:0xf
    v_add_f32_dpp v108, v66, v67 quad_perm:[0,1,2,3] row_mask:0x3 bank_mask:0xf
    v_smfmac_f32_16x16x64_bf16 v[80:83], v[24:27], v[224:231], v23
    v_add_f32_dpp v105, v68, v69 quad_perm:[0,1,2,3] row_mask:0x3 bank_mask:0xf
    v_add_f32_dpp v109, v70, v71 quad_perm:[0,1,2,3] row_mask:0x3 bank_mask:0xf
    v_smfmac_f32_16x16x64_bf16 v[84:87], v[24:27], v[232:239], v23
    v_add_f32_dpp v106, v72, v73 quad_perm:[0,1,2,3] row_mask:0x3 bank_mask:0xf
    v_add_f32_dpp v110, v74, v75 quad_perm:[0,1,2,3] row_mask:0x3 bank_mask:0xf
    v_smfmac_f32_16x16x64_bf16 v[88:91], v[24:27], v[240:247], v23
    v_add_f32_dpp v107, v76, v77 quad_perm:[0,1,2,3] row_mask:0x3 bank_mask:0xf
    v_add_f32_dpp v111, v78, v79 quad_perm:[0,1,2,3] row_mask:0x3 bank_mask:0xf
    v_smfmac_f32_16x16x64_bf16 v[92:95], v[24:27], v[248:255], v23
    v_add_f32_dpp v104, v80, v81 quad_perm:[0,1,2,3] row_mask:0xc bank_mask:0xf
    v_add_f32_dpp v108, v82, v83 quad_perm:[0,1,2,3] row_mask:0xc bank_mask:0xf
    v_add_f32_dpp v105, v84, v85 quad_perm:[0,1,2,3] row_mask:0xc bank_mask:0xf
    v_add_f32_dpp v109, v86, v87 quad_perm:[0,1,2,3] row_mask:0xc bank_mask:0xf
    v_mov_b64 v[62:63], 0
    v_add_f32_dpp v106, v88, v89 quad_perm:[0,1,2,3] row_mask:0xc bank_mask:0xf
    v_add_f32_dpp v110, v90, v91 quad_perm:[0,1,2,3] row_mask:0xc bank_mask:0xf
    s_nop 0
    v_add_f32_dpp v107, v92, v93 quad_perm:[0,1,2,3] row_mask:0xc bank_mask:0xf
    v_add_f32_dpp v111, v94, v95 quad_perm:[0,1,2,3] row_mask:0xc bank_mask:0xf
    s_mov_b32 exec_lo, 0xff0000ff
    s_mov_b32 exec_hi, 0xff0000ff
    ds_write_b128 v3, v[104:107]
    ds_write_b128 v3, v[108:111] offset:256
    s_mov_b64 exec, -1
    s_waitcnt lgkmcnt(0)
    s_barrier
    ds_read_b32 v24, v4 offset:0
    ds_read_b32 v25, v4 offset:2176
    ds_read_b32 v26, v4 offset:4352
    ds_read_b32 v27, v4 offset:6528
    s_waitcnt lgkmcnt(2)
    v_add_f32 v24, v24, v25
    s_waitcnt lgkmcnt(0)
    v_add_f32 v26, v26, v27
    v_add_f32 v24, v24, v26
    s_nop 1
    v_add_f32_dpp v24, v24, v24 quad_perm:[1,0,3,2] row_mask:0xf bank_mask:0xf
    s_nop 1
    v_add_f32_dpp v24, v24, v24 quad_perm:[2,3,0,1] row_mask:0xf bank_mask:0xf
    v_cvt_pk_bf16_f32 v24, 0, v24
    v_mov_b32 v26, 0xc0135761
    v_add_f32 v24, v24, v17
    v_cvt_pk_bf16_f32 v24, 0, v24
    v_mul_f32 v25, v24, v24
    v_fmac_f32 v26, 0xbdd2d3e8, v25
    v_mul_f32 v25, v26, v24
    v_exp_f32 v25, v25
    s_nop 0
    v_add_f32 v25, 1.0, v25
    v_rcp_f32 v25, v25
    s_nop 0
    v_mul_f32 v24, v24, v25
    v_cvt_pk_bf16_f32 v24, v24, v24
    ds_write_b16 v5, v24
    s_waitcnt lgkmcnt(0)
    s_barrier
    ds_read_b128 v[24:27], v6
    s_waitcnt lgkmcnt(0)
    v_smfmac_f32_16x16x64_bf16 v[32:35], v[24:27], v[128:135], v23
    v_mov_b32 v6, 0xffffff00
    s_nop 0
    v_smfmac_f32_16x16x64_bf16 v[36:39], v[24:27], v[136:143], v23
    s_nop 1
    v_smfmac_f32_16x16x64_bf16 v[40:43], v[24:27], v[144:151], v23
    s_nop 1
    v_smfmac_f32_16x16x64_bf16 v[44:47], v[24:27], v[152:159], v23
    v_add_f32_dpp v28, v32, v33 quad_perm:[0,1,2,3] row_mask:0x1 bank_mask:0xf
    v_add_f32_dpp v30, v34, v35 quad_perm:[0,1,2,3] row_mask:0x1 bank_mask:0xf
    v_smfmac_f32_16x16x64_bf16 v[48:51], v[24:27], v[160:167], v23
    v_add_f32_dpp v29, v36, v37 quad_perm:[0,1,2,3] row_mask:0x1 bank_mask:0xf
    v_add_f32_dpp v31, v38, v39 quad_perm:[0,1,2,3] row_mask:0x1 bank_mask:0xf
    v_smfmac_f32_16x16x64_bf16 v[52:55], v[24:27], v[168:175], v23
    v_add_f32_dpp v28, v40, v41 quad_perm:[0,1,2,3] row_mask:0x2 bank_mask:0xf
    v_add_f32_dpp v30, v42, v43 quad_perm:[0,1,2,3] row_mask:0x2 bank_mask:0xf
    v_smfmac_f32_16x16x64_bf16 v[56:59], v[24:27], v[176:183], v23
    v_add_f32_dpp v29, v44, v45 quad_perm:[0,1,2,3] row_mask:0x2 bank_mask:0xf
    v_add_f32_dpp v31, v46, v47 quad_perm:[0,1,2,3] row_mask:0x2 bank_mask:0xf
    v_smfmac_f32_16x16x64_bf16 v[60:63], v[24:27], v[184:191], v23
    v_add_f32_dpp v28, v48, v49 quad_perm:[0,1,2,3] row_mask:0x4 bank_mask:0xf
    v_add_f32_dpp v30, v50, v51 quad_perm:[0,1,2,3] row_mask:0x4 bank_mask:0xf
    v_add_f32_dpp v29, v52, v53 quad_perm:[0,1,2,3] row_mask:0x4 bank_mask:0xf
    v_add_f32_dpp v31, v54, v55 quad_perm:[0,1,2,3] row_mask:0x4 bank_mask:0xf
    s_nop 0
    v_add_f32_dpp v28, v56, v57 quad_perm:[0,1,2,3] row_mask:0x8 bank_mask:0xf
    v_add_f32_dpp v30, v58, v59 quad_perm:[0,1,2,3] row_mask:0x8 bank_mask:0xf
    s_nop 0
    v_add_f32_dpp v29, v60, v61 quad_perm:[0,1,2,3] row_mask:0x8 bank_mask:0xf
    v_add_f32_dpp v31, v62, v63 quad_perm:[0,1,2,3] row_mask:0x8 bank_mask:0xf
    v_and_or_b32 v28, v28, v6, s26
    v_and_or_b32 v29, v29, v6, s26
    v_and_or_b32 v30, v30, v6, s26
    v_and_or_b32 v31, v31, v6, s26
    buffer_store_dwordx4 v[28:31], v8, s[48:51], s13 offen sc1
    s_nop 1
    s_endpgm
L_proj:
    s_getpc_b64 s[98:99]
L_pc0:
    s_sub_u32 s98, s98, L_pc0-adaLN_cond__gqa_block_cached__mixer_channel_mlp__decode_kernel
    s_subb_u32 s99, s99, 0
    s_and_b32 s4, s2, 56
    s_add_u32 s4, s4, s3
    s_lshl_b32 s4, s4, 9
    v_lshl_add_u32 v24, v0, 3, s4
    global_load_dwordx2 v[36:37], v24, s[98:99]
    s_and_b32 s14, s2, 7
    s_lshl_b32 s14, s14, 3
    s_lshr_b32 s4, s2, 3
    s_add_u32 s14, s14, s4
    s_lshl_b32 s4, s3, 6
    v_add_u32 v7, s4, v0
    v_bfe_u32 v18, v7, 3, 6
    v_mul_u32_u24 v18, 98304, v18
    v_and_b32 v31, 7, v7
    v_lshl_add_u32 v18, v31, 4, v18
    s_and_b32 s15, s14, 1
    s_lshr_b32 s6, s14, 1
    s_lshl_b32 s6, s6, 7
    s_mul_i32 s13, s15, 6291456
    s_add_u32 s13, s13, s6
    v_bfe_u32 v30, v7, 3, 6
    v_lshlrev_b32 v30, 6, v30
    v_and_b32 v24, 3, v7
    v_lshl_add_u32 v30, v24, 4, v30
    v_bfe_u32 v24, v7, 2, 1
    v_lshl_add_u32 v30, v24, 3, v30
    s_waitcnt lgkmcnt(0)
    s_mov_b32 s60, s36
    s_mov_b32 s61, s37
    s_mov_b32 s62, 0x1000
    s_mov_b32 s63, 0x20000
    buffer_load_dwordx2 v[12:13], v30, s[60:63], 0 offen
    s_mov_b32 s60, s16
    s_mov_b32 s61, s17
    buffer_load_dwordx2 v[14:15], v30, s[60:63], 0 offen
    s_mov_b32 s48, s44
    s_mov_b32 s49, s45
    s_mov_b32 s50, 0x400000
    s_mov_b32 s51, 0x20000
    buffer_load_dword v22, off, s[48:51], 0 sc1
    s_mov_b32 s56, s38
    s_mov_b32 s57, s39
    s_mov_b32 s58, 0xc00000
    s_mov_b32 s59, 0x20000
    s_add_u32 s4, s13, 0
    buffer_load_dwordx4 v[64:67], v18, s[56:59], s4 offen nt
    s_add_u32 s4, s4, 12288
    buffer_load_dwordx4 v[68:71], v18, s[56:59], s4 offen nt
    s_add_u32 s4, s4, 12288
    buffer_load_dwordx4 v[72:75], v18, s[56:59], s4 offen nt
    s_add_u32 s4, s4, 12288
    buffer_load_dwordx4 v[76:79], v18, s[56:59], s4 offen nt
    s_add_u32 s4, s4, 12288
    buffer_load_dwordx4 v[80:83], v18, s[56:59], s4 offen nt
    s_add_u32 s4, s4, 12288
    buffer_load_dwordx4 v[84:87], v18, s[56:59], s4 offen nt
    s_add_u32 s4, s4, 12288
    buffer_load_dwordx4 v[88:91], v18, s[56:59], s4 offen nt
    s_add_u32 s4, s4, 12288
    buffer_load_dwordx4 v[92:95], v18, s[56:59], s4 offen nt
    s_mov_b32 s64, 0x05040100
    s_mov_b32 s65, 0x07060302
    s_mov_b32 s66, 0xffff0000
    s_lshl_b32 s7, s14, 7
    s_lshr_b32 s46, s14, 4
    s_lshl_b32 s46, s46, 2
    s_lshl_b32 s47, s15, 15
    s_lshl_b32 s5, s6, 2
    s_add_u32 s47, s47, s5
    s_add_u32 s47, s47, 131072
    s_lshl_b32 s4, s3, 6
    v_add_u32 v7, s4, v0
    v_bfe_u32 v30, v7, 3, 6
    v_lshlrev_b32 v30, 6, v30
    v_and_b32 v24, 3, v7
    v_lshl_add_u32 v30, v24, 4, v30
    v_bfe_u32 v24, v7, 2, 1
    v_lshl_add_u32 v30, v24, 3, v30
    v_bfe_u32 v1, v30, 11, 1
    v_mul_u32_u24 v1, 2176, v1
    v_and_b32 v24, 2047, v30
    v_add_u32 v1, v1, v24
    v_and_b32 v2, 1, v7
    v_mul_u32_u24 v2, 2176, v2
    v_bfe_u32 v24, v7, 6, 3
    v_lshl_add_u32 v2, v24, 7, v2
    v_bfe_u32 v24, v7, 4, 2
    v_lshl_add_u32 v2, v24, 5, v2
    v_bfe_u32 v24, v7, 1, 1
    v_lshl_add_u32 v2, v24, 4, v2
    v_bfe_u32 v3, v7, 6, 3
    v_mul_u32_u24 v3, 1088, v3
    v_bfe_u32 v24, v7, 1, 1
    v_mul_u32_u24 v24, 544, v24
    v_add_u32 v3, v3, v24
    v_and_b32 v24, 1, v7
    v_lshl_add_u32 v3, v24, 8, v3
    v_bfe_u32 v24, v7, 2, 2
    v_lshl_add_u32 v3, v24, 5, v3
    v_bfe_u32 v24, v7, 4, 1
    v_lshl_add_u32 v3, v24, 4, v3
    v_add_u32 v3, 17152, v3
    v_and_b32 v4, 3, v7
    v_mul_u32_u24 v4, 544, v4
    v_bfe_u32 v24, v7, 2, 7
    v_lshl_add_u32 v4, v24, 2, v4
    v_add_u32 v4, 17152, v4
    v_bfe_u32 v5, v7, 8, 1
    v_lshlrev_b32 v5, 7, v5
    v_bfe_u32 v24, v7, 2, 3
    v_lshl_add_u32 v5, v24, 4, v5
    v_bfe_u32 v24, v7, 5, 2
    v_lshl_add_u32 v5, v24, 2, v5
    v_bfe_u32 v24, v7, 7, 1
    v_lshl_add_u32 v5, v24, 1, v5
    v_add_u32 v5, 25856, v5
    v_bfe_u32 v17, v7, 3, 6
    v_lshlrev_b32 v17, 16, v17
    v_and_b32 v31, 7, v7
    v_lshl_add_u32 v17, v31, 4, v17
    s_lshl_b32 s4, s3, 3
    v_mov_b32 v19, s4
    s_and_b32 s4, s4, 32
    v_mov_b32 v23, s4
    s_mul_i32 s8, s14, 16384
    s_add_u32 s8, s8, 1048576
    s_lshr_b32 s9, s14, 1
    s_mul_i32 s9, s9, 16640
    s_lshl_b32 s10, s15, 7
    s_add_u32 s9, s9, s10
    s_add_u32 s10, s9, 3145728
    s_add_u32 s9, s9, 2097152
    s_lshl_b32 s11, s14, 7
    s_add_u32 s11, s11, 393216
    s_waitcnt vmcnt(8)
    v_readfirstlane_b32 s27, v22
    s_mul_i32 s26, s27, 0x9e3779b1
    s_lshr_b32 s26, s26, 12
    s_or_b32 s26, s26, 1
    s_add_u32 s27, s27, s26
    s_and_b32 s26, s27, 255
    s_and_b32 s1, s27, 0xffff
    v_lshlrev_b32 v32, 16, v12
    v_and_b32 v33, s66, v12
    v_lshlrev_b32 v34, 16, v13
    v_and_b32 v35, s66, v13
    v_mul_f32 v24, 0xbfb8aa3b, v32
    v_mul_f32 v25, 0xbfb8aa3b, v33
    v_mul_f32 v26, 0xbfb8aa3b, v34
    v_mul_f32 v27, 0xbfb8aa3b, v35
    v_exp_f32 v24, v24
    v_exp_f32 v25, v25
    v_exp_f32 v26, v26
    v_exp_f32 v27, v27
    v_add_f32 v24, 1.0, v24
    v_add_f32 v25, 1.0, v25
    v_add_f32 v26, 1.0, v26
    v_add_f32 v27, 1.0, v27
    v_rcp_f32 v24, v24
    v_rcp_f32 v25, v25
    v_rcp_f32 v26, v26
    v_rcp_f32 v27, v27
    v_mul_f32 v24, v24, v32
    v_mul_f32 v25, v25, v33
    v_mul_f32 v26, v26, v34
    v_mul_f32 v27, v27, v35
    v_cvt_pk_bf16_f32 v28, v24, v25
    v_cvt_pk_bf16_f32 v29, v26, v27
    ds_write_b64 v1, v[28:29] offset:8448
    v_lshlrev_b32 v8, 16, v14
    v_and_b32 v9, s66, v14
    v_lshlrev_b32 v10, 16, v15
    v_and_b32 v11, s66, v15
    v_add_f32 v28, v8, v9
    v_mul_f32 v29, v8, v8
    v_add_f32 v24, v10, v11
    v_fmac_f32 v29, v9, v9
    v_add_f32 v28, v28, v24
    v_fmac_f32 v29, v10, v10
    v_fmac_f32 v29, v11, v11
    v_add_f32_dpp v28, v28, v28 row_ror:8 row_mask:0xf bank_mask:0xf
    s_nop 0
    v_add_f32_dpp v29, v29, v29 row_ror:8 row_mask:0xf bank_mask:0xf
    s_nop 0
    v_add_f32_dpp v28, v28, v28 row_ror:4 row_mask:0xf bank_mask:0xf
    v_add_f32_dpp v29, v29, v29 row_ror:4 row_mask:0xf bank_mask:0xf
    s_nop 0
    v_add_f32_dpp v28, v28, v28 row_ror:2 row_mask:0xf bank_mask:0xf
    v_add_f32_dpp v29, v29, v29 row_ror:2 row_mask:0xf bank_mask:0xf
    s_nop 0
    v_add_f32_dpp v28, v28, v28 row_ror:1 row_mask:0xf bank_mask:0xf
    v_add_f32_dpp v29, v29, v29 row_ror:1 row_mask:0xf bank_mask:0xf
    s_nop 0
    v_add_f32_dpp v28, v28, v28 row_bcast:15 row_mask:0xa bank_mask:0xf
    v_add_f32_dpp v29, v29, v29 row_bcast:15 row_mask:0xa bank_mask:0xf
    s_nop 0
    v_add_f32_dpp v28, v28, v28 row_bcast:31 row_mask:0xc bank_mask:0xf
    v_add_f32_dpp v29, v29, v29 row_bcast:31 row_mask:0xc bank_mask:0xf
    s_mov_b32 exec_lo, 0x0
    s_mov_b32 exec_hi, 0x80000000
    ds_write_b64 v19, v[28:29] offset:27136
    s_mov_b64 exec, -1
    s_waitcnt lgkmcnt(0)
    s_barrier
    ds_read_b128 v[24:27], v23 offset:27136
    ds_read_b128 v[28:31], v23 offset:27152
    s_waitcnt lgkmcnt(0)
    v_pk_add_f32 v[24:25], v[24:25], v[28:29]
    v_pk_add_f32 v[26:27], v[26:27], v[30:31]
    v_pk_add_f32 v[28:29], v[24:25], v[26:27]
    v_mul_f32 v28, 0x3a800000, v28
    v_mul_f32 v29, 0x3a800000, v29
    v_fma_f32 v29, -v28, v28, v29
    v_max_f32 v29, 0, v29
    v_cvt_pk_bf16_f32 v28, 0, v28
    v_cvt_pk_bf16_f32 v29, 0, v29
    v_add_f32 v29, 0x3727c5ac, v29
    v_cvt_pk_bf16_f32 v29, 0, v29
    v_sqrt_f32 v29, v29
    v_sub_f32 v8, v8, v28
    v_sub_f32 v9, v9, v28
    v_sub_f32 v10, v10, v28
    v_sub_f32 v11, v11, v28
    v_cvt_pk_bf16_f32 v29, 0, v29
    v_rcp_f32 v29, v29
    v_cvt_pk_bf16_f32 v8, 0, v8
    v_cvt_pk_bf16_f32 v9, 0, v9
    v_cvt_pk_bf16_f32 v10, 0, v10
    v_cvt_pk_bf16_f32 v11, 0, v11
    v_mul_f32 v8, v8, v29
    v_mul_f32 v9, v9, v29
    v_mul_f32 v10, v10, v29
    v_mul_f32 v11, v11, v29
    v_cvt_pk_bf16_f32 v8, 0, v8
    v_cvt_pk_bf16_f32 v9, 0, v9
    v_cvt_pk_bf16_f32 v10, 0, v10
    v_cvt_pk_bf16_f32 v11, 0, v11
    s_mov_b32 s56, s22
    s_mov_b32 s57, s23
    s_mov_b32 s58, 0x800000
    s_mov_b32 s59, 0x20000
    s_add_u32 s4, s7, 0
    buffer_load_dwordx4 v[128:131], v17, s[56:59], s4 offen nt
    s_add_u32 s4, s4, 8192
    buffer_load_dwordx4 v[132:135], v17, s[56:59], s4 offen nt
    s_add_u32 s4, s4, 8192
    buffer_load_dwordx4 v[136:139], v17, s[56:59], s4 offen nt
    s_add_u32 s4, s4, 8192
    buffer_load_dwordx4 v[140:143], v17, s[56:59], s4 offen nt
    s_add_u32 s4, s4, 8192
    buffer_load_dwordx4 v[144:147], v17, s[56:59], s4 offen nt
    s_add_u32 s4, s4, 8192
    buffer_load_dwordx4 v[148:151], v17, s[56:59], s4 offen nt
    s_add_u32 s4, s4, 8192
    buffer_load_dwordx4 v[152:155], v17, s[56:59], s4 offen nt
    s_add_u32 s4, s4, 8192
    buffer_load_dwordx4 v[156:159], v17, s[56:59], s4 offen nt
    s_waitcnt vmcnt(8)
    v_perm_b32 v24, v68, v64, s64
    v_perm_b32 v68, v68, v64, s65
    v_mov_b32 v64, v24
    v_perm_b32 v24, v77, v73, s64
    v_perm_b32 v77, v77, v73, s65
    v_mov_b32 v73, v24
    v_perm_b32 v24, v86, v82, s64
    v_perm_b32 v86, v86, v82, s65
    v_mov_b32 v82, v24
    v_perm_b32 v24, v95, v91, s64
    v_perm_b32 v95, v95, v91, s65
    v_mov_b32 v91, v24
    v_perm_b32 v24, v69, v65, s64
    v_perm_b32 v25, v69, v65, s65
    v_perm_b32 v65, v76, v72, s64
    v_perm_b32 v69, v76, v72, s65
    v_mov_b32 v72, v24
    v_mov_b32 v76, v25
    v_perm_b32 v24, v70, v66, s64
    v_perm_b32 v25, v70, v66, s65
    v_perm_b32 v66, v84, v80, s64
    v_perm_b32 v70, v84, v80, s65
    v_mov_b32 v80, v24
    v_mov_b32 v84, v25
    v_perm_b32 v24, v71, v67, s64
    v_perm_b32 v25, v71, v67, s65
    v_perm_b32 v67, v92, v88, s64
    v_perm_b32 v71, v92, v88, s65
    v_mov_b32 v88, v24
    v_mov_b32 v92, v25
    v_perm_b32 v24, v78, v74, s64
    v_perm_b32 v25, v78, v74, s65
    v_perm_b32 v74, v85, v81, s64
    v_perm_b32 v78, v85, v81, s65
    v_mov_b32 v81, v24
    v_mov_b32 v85, v25
    v_perm_b32 v24, v79, v75, s64
    v_perm_b32 v25, v79, v75, s65
    v_perm_b32 v75, v93, v89, s64
    v_perm_b32 v79, v93, v89, s65
    v_mov_b32 v89, v24
    v_mov_b32 v93, v25
    v_perm_b32 v24, v87, v83, s64
    v_perm_b32 v25, v87, v83, s65
    v_perm_b32 v83, v94, v90, s64
    v_perm_b32 v87, v94, v90, s65
    v_mov_b32 v90, v24
    v_mov_b32 v94, v25
    s_lshl_b32 s4, s15, 10
    v_add_u32 v31, s4, v2
    ds_read_b128 v[24:27], v31 offset:8448
    s_waitcnt lgkmcnt(0)
    v_mfma_f32_16x16x32_bf16 v[32:35], v[64:67], v[24:27], 0
    v_mfma_f32_16x16x32_bf16 v[36:39], v[68:71], v[24:27], 0
    v_mfma_f32_16x16x32_bf16 v[40:43], v[72:75], v[24:27], 0
    v_mfma_f32_16x16x32_bf16 v[44:47], v[76:79], v[24:27], 0
    v_mfma_f32_16x16x32_bf16 v[48:51], v[80:83], v[24:27], 0
    v_mfma_f32_16x16x32_bf16 v[52:55], v[84:87], v[24:27], 0
    v_mfma_f32_16x16x32_bf16 v[56:59], v[88:91], v[24:27], 0
    v_mfma_f32_16x16x32_bf16 v[60:63], v[92:95], v[24:27], 0
    s_mov_b32 exec_lo, 0xf000f0
    s_mov_b32 exec_hi, 0xf000f0
    s_nop 1
    v_mov_b64 v[32:33], v[40:41]
    v_mov_b64 v[34:35], v[42:43]
    v_mov_b64 v[36:37], v[44:45]
    v_mov_b64 v[38:39], v[46:47]
    s_mov_b32 exec_lo, 0xf000f00
    s_mov_b32 exec_hi, 0xf000f00
    v_mov_b64 v[32:33], v[48:49]
    v_mov_b64 v[34:35], v[50:51]
    v_mov_b64 v[36:37], v[52:53]
    v_mov_b64 v[38:39], v[54:55]
    s_mov_b32 exec_lo, 0xf000f000
    s_mov_b32 exec_hi, 0xf000f000
    s_nop 1
    v_mov_b64 v[32:33], v[56:57]
    v_mov_b64 v[34:35], v[58:59]
    v_mov_b64 v[36:37], v[60:61]
    v_mov_b64 v[38:39], v[62:63]
    s_mov_b32 exec_lo, 0x33333333
    s_mov_b32 exec_hi, 0xcccccccc
    ds_write_b128 v3, v[32:35]
    ds_write_b128 v3, v[36:39] offset:128
    s_mov_b64 exec, -1
    s_waitcnt lgkmcnt(0)
    s_barrier
    ds_read_b32 v24, v4 offset:0
    ds_read_b32 v25, v4 offset:2176
    ds_read_b32 v26, v4 offset:4352
    ds_read_b32 v27, v4 offset:6528
    s_waitcnt lgkmcnt(2)
    v_add_f32 v24, v24, v25
    s_waitcnt lgkmcnt(0)
    v_add_f32 v26, v26, v27
    v_add_f32 v24, v24, v26
    s_nop 1
    v_add_f32_dpp v24, v24, v24 quad_perm:[1,0,3,2] row_mask:0xf bank_mask:0xf
    s_nop 1
    v_add_f32_dpp v24, v24, v24 quad_perm:[2,3,0,1] row_mask:0xf bank_mask:0xf
    v_subrev_u32 v25, 25856, v5
    v_lshlrev_b32 v25, 1, v25
    ds_write_b32 v25, v24 offset:26112
    s_waitcnt lgkmcnt(0)
    s_barrier
    s_cmp_lg_u32 s3, 0
    s_cbranch_scc1 L_skip_55
    v_lshlrev_b32 v28, 3, v0
    ds_read_b64 v[30:31], v28 offset:26112
    v_bfe_u32 v29, v0, 5, 1
    v_lshlrev_b32 v29, 14, v29
    v_and_b32 v28, 31, v0
    v_lshl_add_u32 v29, v28, 4, v29
    v_mov_b32 v25, s27
    v_mov_b32 v27, s27
    s_waitcnt lgkmcnt(0)
    v_mov_b32 v24, v30
    v_mov_b32 v26, v31
    buffer_store_dwordx4 v[24:27], v29, s[48:51], s47 offen sc1
    s_mov_b64 exec, -1
    s_nop 0
L_skip_55:
    s_mov_b32 s56, s22
    s_mov_b32 s57, s23
    s_mov_b32 s58, 0x800000
    s_mov_b32 s59, 0x20000
    s_add_u32 s4, s7, 4194304
    buffer_load_dwordx4 v[160:163], v17, s[56:59], s4 offen nt
    s_add_u32 s4, s4, 8192
    buffer_load_dwordx4 v[164:167], v17, s[56:59], s4 offen nt
    s_add_u32 s4, s4, 8192
    buffer_load_dwordx4 v[168:171], v17, s[56:59], s4 offen nt
    s_add_u32 s4, s4, 8192
    buffer_load_dwordx4 v[172:175], v17, s[56:59], s4 offen nt
    s_add_u32 s4, s4, 8192
    buffer_load_dwordx4 v[176:179], v17, s[56:59], s4 offen nt
    s_add_u32 s4, s4, 8192
    buffer_load_dwordx4 v[180:183], v17, s[56:59], s4 offen nt
    s_add_u32 s4, s4, 8192
    buffer_load_dwordx4 v[184:187], v17, s[56:59], s4 offen nt
    s_add_u32 s4, s4, 8192
    buffer_load_dwordx4 v[188:191], v17, s[56:59], s4 offen nt
    v_bfe_u32 v21, v7, 8, 1
    v_lshlrev_b32 v21, 14, v21
    v_bfe_u32 v31, v7, 3, 5
    v_lshl_add_u32 v21, v31, 8, v21
    v_and_b32 v31, 3, v7
    v_lshl_add_u32 v21, v31, 6, v21
    v_bfe_u32 v31, v7, 2, 1
    v_lshl_add_u32 v21, v31, 5, v21
    v_add_u32 v21, 131072, v21
    s_waitcnt vmcnt(8)
    v_perm_b32 v24, v132, v128, s64
    v_perm_b32 v132, v132, v128, s65
    v_mov_b32 v128, v24
    v_perm_b32 v24, v141, v137, s64
    v_perm_b32 v141, v141, v137, s65
    v_mov_b32 v137, v24
    v_perm_b32 v24, v150, v146, s64
    v_perm_b32 v150, v150, v146, s65
    v_mov_b32 v146, v24
    v_perm_b32 v24, v159, v155, s64
    v_perm_b32 v159, v159, v155, s65
    v_mov_b32 v155, v24
    v_perm_b32 v24, v133, v129, s64
    v_perm_b32 v25, v133, v129, s65
    v_perm_b32 v129, v140, v136, s64
    v_perm_b32 v133, v140, v136, s65
    v_mov_b32 v136, v24
    v_mov_b32 v140, v25
    v_perm_b32 v24, v134, v130, s64
    v_perm_b32 v25, v134, v130, s65
    v_perm_b32 v130, v148, v144, s64
    v_perm_b32 v134, v148, v144, s65
    v_mov_b32 v144, v24
    v_mov_b32 v148, v25
    v_perm_b32 v24, v135, v131, s64
    v_perm_b32 v25, v135, v131, s65
    v_perm_b32 v131, v156, v152, s64
    v_perm_b32 v135, v156, v152, s65
    v_mov_b32 v152, v24
    v_mov_b32 v156, v25
    v_perm_b32 v24, v142, v138, s64
    v_perm_b32 v25, v142, v138, s65
    v_perm_b32 v138, v149, v145, s64
    v_perm_b32 v142, v149, v145, s65
    v_mov_b32 v145, v24
    v_mov_b32 v149, v25
    v_perm_b32 v24, v143, v139, s64
    v_perm_b32 v25, v143, v139, s65
    v_perm_b32 v139, v157, v153, s64
    v_perm_b32 v143, v157, v153, s65
    v_mov_b32 v153, v24
    v_mov_b32 v157, v25
    v_perm_b32 v24, v151, v147, s64
    v_perm_b32 v25, v151, v147, s65
    v_perm_b32 v147, v158, v154, s64
    v_perm_b32 v151, v158, v154, s65
    v_mov_b32 v154, v24
    v_mov_b32 v158, v25
    s_mov_b32 s4, 8192
    s_mov_b32 s5, 32768
    s_mov_b32 s12, 40960
    s_waitcnt vmcnt(4)
    buffer_load_dwordx4 v[32:35], v21, s[48:51], 0 offen offset:0 sc1
    buffer_load_dwordx4 v[36:39], v21, s[48:51], 0 offen offset:16 sc1
    buffer_load_dwordx4 v[40:43], v21, s[48:51], s5 offen offset:0 sc1
    buffer_load_dwordx4 v[44:47], v21, s[48:51], s5 offen offset:16 sc1
    buffer_load_dwordx4 v[48:51], v21, s[48:51], s4 offen offset:0 sc1
    buffer_load_dwordx4 v[52:55], v21, s[48:51], s4 offen offset:16 sc1
    buffer_load_dwordx4 v[56:59], v21, s[48:51], s12 offen offset:0 sc1
    buffer_load_dwordx4 v[60:63], v21, s[48:51], s12 offen offset:16 sc1
    s_lshr_b32 s47, s14, 3
    s_and_b32 s68, s14, 7
    s_lshl_b32 s100, s68, 3
    s_add_u32 s100, s100, s3
    s_mul_i32 s69, s47, 64
    s_add_u32 s100, s100, s69
    s_add_u32 s68, s68, 24
    v_bfe_u32 v12, v0, 1, 1
    v_lshlrev_b32 v12, 10, v12
    v_bfe_u32 v13, v0, 2, 2
    v_lshl_add_u32 v12, v13, 8, v12
    v_and_b32 v13, 1, v0
    v_lshl_add_u32 v12, v13, 6, v12
    v_bfe_u32 v13, v0, 4, 2
    v_lshl_add_u32 v12, v13, 4, v12
    v_lshlrev_b32 v13, 4, v0
    s_waitcnt vmcnt(8)
    v_perm_b32 v24, v164, v160, s64
    v_perm_b32 v164, v164, v160, s65
    v_mov_b32 v160, v24
    v_perm_b32 v24, v173, v169, s64
    v_perm_b32 v173, v173, v169, s65
    v_mov_b32 v169, v24
    v_perm_b32 v24, v182, v178, s64
    v_perm_b32 v182, v182, v178, s65
    v_mov_b32 v178, v24
    v_perm_b32 v24, v191, v187, s64
    v_perm_b32 v191, v191, v187, s65
    v_mov_b32 v187, v24
    v_perm_b32 v24, v165, v161, s64
    v_perm_b32 v25, v165, v161, s65
    v_perm_b32 v161, v172, v168, s64
    v_perm_b32 v165, v172, v168, s65
    v_mov_b32 v168, v24
    v_mov_b32 v172, v25
    v_perm_b32 v24, v166, v162, s64
    v_perm_b32 v25, v166, v162, s65
    v_perm_b32 v162, v180, v176, s64
    v_perm_b32 v166, v180, v176, s65
    v_mov_b32 v176, v24
    v_mov_b32 v180, v25
    v_perm_b32 v24, v167, v163, s64
    v_perm_b32 v25, v167, v163, s65
    v_perm_b32 v163, v188, v184, s64
    v_perm_b32 v167, v188, v184, s65
    v_mov_b32 v184, v24
    v_mov_b32 v188, v25
    v_perm_b32 v24, v174, v170, s64
    v_perm_b32 v25, v174, v170, s65
    v_perm_b32 v170, v181, v177, s64
    v_perm_b32 v174, v181, v177, s65
    v_mov_b32 v177, v24
    v_mov_b32 v181, v25
    v_perm_b32 v24, v175, v171, s64
    v_perm_b32 v25, v175, v171, s65
    v_perm_b32 v171, v189, v185, s64
    v_perm_b32 v175, v189, v185, s65
    v_mov_b32 v185, v24
    v_mov_b32 v189, v25
    v_perm_b32 v24, v183, v179, s64
    v_perm_b32 v25, v183, v179, s65
    v_perm_b32 v179, v190, v186, s64
    v_perm_b32 v183, v190, v186, s65
    v_mov_b32 v186, v24
    v_mov_b32 v190, v25
    s_waitcnt vmcnt(0)
    s_mov_b32 s67, 262144
    s_branch L_chk_58
L_poll_56:
    buffer_load_dwordx4 v[32:35], v21, s[48:51], 0 offen offset:0 sc1
    buffer_load_dwordx4 v[36:39], v21, s[48:51], 0 offen offset:16 sc1
    buffer_load_dwordx4 v[40:43], v21, s[48:51], s5 offen offset:0 sc1
    buffer_load_dwordx4 v[44:47], v21, s[48:51], s5 offen offset:16 sc1
    buffer_load_dwordx4 v[48:51], v21, s[48:51], s4 offen offset:0 sc1
    buffer_load_dwordx4 v[52:55], v21, s[48:51], s4 offen offset:16 sc1
    buffer_load_dwordx4 v[56:59], v21, s[48:51], s12 offen offset:0 sc1
    buffer_load_dwordx4 v[60:63], v21, s[48:51], s12 offen offset:16 sc1
    s_waitcnt vmcnt(0)
L_chk_58:
    v_bitop3_b32 v24, v33, v35, s27 bitop3:0x7e
    v_bitop3_b32 v24, v24, v37, s27 bitop3:0xf6
    v_bitop3_b32 v24, v24, v39, s27 bitop3:0xf6
    v_bitop3_b32 v24, v24, v41, s27 bitop3:0xf6
    v_bitop3_b32 v24, v24, v43, s27 bitop3:0xf6
    v_bitop3_b32 v24, v24, v45, s27 bitop3:0xf6
    v_bitop3_b32 v24, v24, v47, s27 bitop3:0xf6
    v_bitop3_b32 v24, v24, v49, s27 bitop3:0xf6
    v_bitop3_b32 v24, v24, v51, s27 bitop3:0xf6
    v_bitop3_b32 v24, v24, v53, s27 bitop3:0xf6
    v_bitop3_b32 v24, v24, v55, s27 bitop3:0xf6
    v_bitop3_b32 v24, v24, v57, s27 bitop3:0xf6
    v_bitop3_b32 v24, v24, v59, s27 bitop3:0xf6
    v_bitop3_b32 v24, v24, v61, s27 bitop3:0xf6
    v_bitop3_b32 v24, v24, v63, s27 bitop3:0xf6
    v_cmp_ne_u32 vcc, 0, v24
    s_cbranch_vccz L_ok_57
    s_sleep 4
    s_sub_u32 s67, s67, 1
    s_cbranch_scc0 L_poll_56
L_ok_57:
    v_add_f32 v24, v48, v56
    v_add_f32 v25, v50, v58
    v_add_f32 v26, v52, v60
    v_add_f32 v27, v54, v62
    v_add_f32 v32, v32, v40
    v_add_f32 v33, v34, v42
    v_add_f32 v34, v36, v44
    v_add_f32 v35, v38, v46
    v_cvt_pk_bf16_f32 v24, 0, v24
    v_cvt_pk_bf16_f32 v25, 0, v25
    v_cvt_pk_bf16_f32 v26, 0, v26
    v_cvt_pk_bf16_f32 v27, 0, v27
    v_add_f32 v24, 1.0, v24
    v_add_f32 v25, 1.0, v25
    v_add_f32 v26, 1.0, v26
    v_add_f32 v27, 1.0, v27
    v_cvt_pk_bf16_f32 v24, 0, v24
    v_cvt_pk_bf16_f32 v25, 0, v25
    v_cvt_pk_bf16_f32 v26, 0, v26
    v_cvt_pk_bf16_f32 v27, 0, v27
    v_pk_mul_f32 v[8:9], v[8:9], v[24:25]
    v_pk_mul_f32 v[10:11], v[10:11], v[26:27]
    v_cvt_pk_bf16_f32 v8, 0, v8
    v_cvt_pk_bf16_f32 v9, 0, v9
    v_cvt_pk_bf16_f32 v10, 0, v10
    v_cvt_pk_bf16_f32 v11, 0, v11
    v_cvt_pk_bf16_f32 v32, 0, v32
    v_cvt_pk_bf16_f32 v33, 0, v33
    v_cvt_pk_bf16_f32 v34, 0, v34
    v_cvt_pk_bf16_f32 v35, 0, v35
    v_pk_add_f32 v[8:9], v[8:9], v[32:33]
    v_pk_add_f32 v[10:11], v[10:11], v[34:35]
    v_cvt_pk_bf16_f32 v24, v8, v9
    v_cvt_pk_bf16_f32 v25, v10, v11
    ds_write_b64 v1, v[24:25] offset:12800
    s_waitcnt lgkmcnt(0)
    s_barrier
    ds_read_b128 v[24:27], v2 offset:12800
    ds_read_b128 v[28:31], v2 offset:13824
    s_waitcnt lgkmcnt(1)
    v_mfma_f32_16x16x32_bf16 v[32:35], v[128:131], v[24:27], 0
    v_mfma_f32_16x16x32_bf16 v[36:39], v[132:135], v[24:27], 0
    v_mfma_f32_16x16x32_bf16 v[40:43], v[136:139], v[24:27], 0
    v_mfma_f32_16x16x32_bf16 v[44:47], v[140:143], v[24:27], 0
    v_mfma_f32_16x16x32_bf16 v[48:51], v[144:147], v[24:27], 0
    v_mfma_f32_16x16x32_bf16 v[52:55], v[148:151], v[24:27], 0
    v_mfma_f32_16x16x32_bf16 v[56:59], v[152:155], v[24:27], 0
    v_mfma_f32_16x16x32_bf16 v[60:63], v[156:159], v[24:27], 0
    s_waitcnt lgkmcnt(0)
    v_mfma_f32_16x16x32_bf16 v[32:35], v[160:163], v[28:31], v[32:35]
    v_mfma_f32_16x16x32_bf16 v[36:39], v[164:167], v[28:31], v[36:39]
    v_mfma_f32_16x16x32_bf16 v[40:43], v[168:171], v[28:31], v[40:43]
    v_mfma_f32_16x16x32_bf16 v[44:47], v[172:175], v[28:31], v[44:47]
    v_mfma_f32_16x16x32_bf16 v[48:51], v[176:179], v[28:31], v[48:51]
    v_mfma_f32_16x16x32_bf16 v[52:55], v[180:183], v[28:31], v[52:55]
    v_mfma_f32_16x16x32_bf16 v[56:59], v[184:187], v[28:31], v[56:59]
    v_mfma_f32_16x16x32_bf16 v[60:63], v[188:191], v[28:31], v[60:63]
    s_mov_b32 exec_lo, 0xf000f0
    s_mov_b32 exec_hi, 0xf000f0
    s_nop 1
    v_mov_b64 v[32:33], v[40:41]
    v_mov_b64 v[34:35], v[42:43]
    v_mov_b64 v[36:37], v[44:45]
    v_mov_b64 v[38:39], v[46:47]
    s_mov_b32 exec_lo, 0xf000f00
    s_mov_b32 exec_hi, 0xf000f00
    v_mov_b64 v[32:33], v[48:49]
    v_mov_b64 v[34:35], v[50:51]
    v_mov_b64 v[36:37], v[52:53]
    v_mov_b64 v[38:39], v[54:55]
    s_mov_b32 exec_lo, 0xf000f000
    s_mov_b32 exec_hi, 0xf000f000
    s_nop 1
    v_mov_b64 v[32:33], v[56:57]
    v_mov_b64 v[34:35], v[58:59]
    v_mov_b64 v[36:37], v[60:61]
    v_mov_b64 v[38:39], v[62:63]
    s_mov_b32 exec_lo, 0x33333333
    s_mov_b32 exec_hi, 0xcccccccc
    ds_write_b128 v3, v[32:35]
    ds_write_b128 v3, v[36:39] offset:128
    s_mov_b64 exec, -1
    s_waitcnt lgkmcnt(0)
    s_barrier
    ds_read_b32 v24, v4 offset:0
    ds_read_b32 v25, v4 offset:2176
    ds_read_b32 v26, v4 offset:4352
    ds_read_b32 v27, v4 offset:6528
    s_waitcnt lgkmcnt(2)
    v_add_f32 v24, v24, v25
    s_waitcnt lgkmcnt(0)
    v_add_f32 v26, v26, v27
    v_add_f32 v24, v24, v26
    s_nop 1
    v_add_f32_dpp v24, v24, v24 quad_perm:[1,0,3,2] row_mask:0xf bank_mask:0xf
    s_nop 1
    v_add_f32_dpp v24, v24, v24 quad_perm:[2,3,0,1] row_mask:0xf bank_mask:0xf
    s_lshl_b32 s12, s7, 1
    s_add_u32 s12, s12, 32768
    v_cvt_pk_bf16_f32 v24, v24, v24
    v_lshl_or_b32 v24, v24, 16, s1
    v_subrev_u32 v25, 25856, v5
    v_lshlrev_b32 v25, 1, v25
    ds_write_b32 v25, v24 offset:26112
    s_waitcnt lgkmcnt(0)
    s_barrier
    s_cmp_lg_u32 s3, 0
    s_cbranch_scc1 L_skip_59
    v_lshlrev_b32 v28, 4, v0
    ds_read_b128 v[24:27], v28 offset:26112
    v_bfe_u32 v29, v0, 4, 1
    v_lshlrev_b32 v29, 14, v29
    v_and_b32 v30, 15, v0
    v_lshl_add_u32 v29, v30, 4, v29
    s_waitcnt lgkmcnt(0)
    s_mov_b32 exec_hi, 0
    buffer_store_dwordx4 v[24:27], v29, s[48:51], s12 offen sc1
    s_mov_b64 exec, -1
    s_nop 0
L_skip_59:
    s_add_u32 s47, s14, 32
    s_and_b32 s15, s47, 1
    s_lshr_b32 s6, s47, 1
    s_lshl_b32 s6, s6, 7
    s_mul_i32 s13, s15, 6291456
    s_add_u32 s13, s13, s6
    s_add_u32 s13, s13, 4096
    s_mov_b32 s56, s38
    s_mov_b32 s57, s39
    s_mov_b32 s58, 0xc00000
    s_mov_b32 s59, 0x20000
    s_add_u32 s4, s13, 0
    buffer_load_dwordx4 v[64:67], v18, s[56:59], s4 offen nt
    s_add_u32 s4, s4, 12288
    buffer_load_dwordx4 v[68:71], v18, s[56:59], s4 offen nt
    s_add_u32 s4, s4, 12288
    buffer_load_dwordx4 v[72:75], v18, s[56:59], s4 offen nt
    s_add_u32 s4, s4, 12288
    buffer_load_dwordx4 v[76:79], v18, s[56:59], s4 offen nt
    s_add_u32 s4, s4, 12288
    buffer_load_dwordx4 v[80:83], v18, s[56:59], s4 offen nt
    s_add_u32 s4, s4, 12288
    buffer_load_dwordx4 v[84:87], v18, s[56:59], s4 offen nt
    s_add_u32 s4, s4, 12288
    buffer_load_dwordx4 v[88:91], v18, s[56:59], s4 offen nt
    s_add_u32 s4, s4, 12288
    buffer_load_dwordx4 v[92:95], v18, s[56:59], s4 offen nt
    s_mov_b32 s100, s15
    s_mov_b32 s101, s6
    v_bfe_u32 v18, v7, 3, 6
    v_mul_u32_u24 v18, 98304, v18
    v_and_b32 v31, 7, v7
    v_lshl_add_u32 v18, v31, 4, v18
    s_lshr_b32 s4, s3, 2
    s_lshl_b32 s4, s4, 24
    v_add_u32 v18, s4, v18
    s_and_b32 s15, s14, 3
    s_lshr_b32 s6, s14, 2
    s_lshl_b32 s6, s6, 7
    s_mul_i32 s13, s15, 3145728
    s_add_u32 s13, s13, s6
    s_add_u32 s13, s13, 4096
    s_mov_b32 s56, s38
    s_mov_b32 s57, s39
    s_mov_b32 s58, 0xc00000
    s_mov_b32 s59, 0x20000
    s_add_u32 s4, s13, 0
    buffer_load_dwordx4 v[96:99], v18, s[56:59], s4 offen nt
    s_add_u32 s4, s4, 12288
    buffer_load_dwordx4 v[100:103], v18, s[56:59], s4 offen nt
    s_add_u32 s4, s4, 12288
    buffer_load_dwordx4 v[104:107], v18, s[56:59], s4 offen nt
    s_add_u32 s4, s4, 12288
    buffer_load_dwordx4 v[108:111], v18, s[56:59], s4 offen nt
    s_add_u32 s4, s4, 12288
    buffer_load_dwordx4 v[112:115], v18, s[56:59], s4 offen nt
    s_add_u32 s4, s4, 12288
    buffer_load_dwordx4 v[116:119], v18, s[56:59], s4 offen nt
    s_add_u32 s4, s4, 12288
    buffer_load_dwordx4 v[120:123], v18, s[56:59], s4 offen nt
    s_add_u32 s4, s4, 12288
    buffer_load_dwordx4 v[124:127], v18, s[56:59], s4 offen nt
    s_mov_b32 s68, s15
    s_mov_b32 s69, s6
    s_mov_b32 s15, s100
    s_mov_b32 s6, s101
    s_waitcnt vmcnt(8)
    s_lshl_b32 s12, s15, 15
    s_lshl_b32 s5, s6, 1
    s_add_u32 s12, s12, s5
    s_add_u32 s12, s12, 262144
    s_lshl_b32 s4, s15, 10
    v_add_u32 v8, s4, v2
    v_mov_b32 v9, 0xffffff00
    v_perm_b32 v24, v68, v64, s64
    v_perm_b32 v68, v68, v64, s65
    v_mov_b32 v64, v24
    v_perm_b32 v24, v77, v73, s64
    v_perm_b32 v77, v77, v73, s65
    v_mov_b32 v73, v24
    v_perm_b32 v24, v86, v82, s64
    v_perm_b32 v86, v86, v82, s65
    v_mov_b32 v82, v24
    v_perm_b32 v24, v95, v91, s64
    v_perm_b32 v95, v95, v91, s65
    v_mov_b32 v91, v24
    v_perm_b32 v24, v69, v65, s64
    v_perm_b32 v25, v69, v65, s65
    v_perm_b32 v65, v76, v72, s64
    v_perm_b32 v69, v76, v72, s65
    v_mov_b32 v72, v24
    v_mov_b32 v76, v25
    v_perm_b32 v24, v70, v66, s64
    v_perm_b32 v25, v70, v66, s65
    v_perm_b32 v66, v84, v80, s64
    v_perm_b32 v70, v84, v80, s65
    v_mov_b32 v80, v24
    v_mov_b32 v84, v25
    v_perm_b32 v24, v71, v67, s64
    v_perm_b32 v25, v71, v67, s65
    v_perm_b32 v67, v92, v88, s64
    v_perm_b32 v71, v92, v88, s65
    v_mov_b32 v88, v24
    v_mov_b32 v92, v25
    v_perm_b32 v24, v78, v74, s64
    v_perm_b32 v25, v78, v74, s65
    v_perm_b32 v74, v85, v81, s64
    v_perm_b32 v78, v85, v81, s65
    v_mov_b32 v81, v24
    v_mov_b32 v85, v25
    v_perm_b32 v24, v79, v75, s64
    v_perm_b32 v25, v79, v75, s65
    v_perm_b32 v75, v93, v89, s64
    v_perm_b32 v79, v93, v89, s65
    v_mov_b32 v89, v24
    v_mov_b32 v93, v25
    v_perm_b32 v24, v87, v83, s64
    v_perm_b32 v25, v87, v83, s65
    v_perm_b32 v83, v94, v90, s64
    v_perm_b32 v87, v94, v90, s65
    v_mov_b32 v90, v24
    v_mov_b32 v94, v25
    ds_read_b128 v[24:27], v8 offset:8448
    s_waitcnt lgkmcnt(0)
    v_mfma_f32_16x16x32_bf16 v[32:35], v[64:67], v[24:27], 0
    v_mfma_f32_16x16x32_bf16 v[36:39], v[68:71], v[24:27], 0
    v_mfma_f32_16x16x32_bf16 v[40:43], v[72:75], v[24:27], 0
    v_mfma_f32_16x16x32_bf16 v[44:47], v[76:79], v[24:27], 0
    v_mfma_f32_16x16x32_bf16 v[48:51], v[80:83], v[24:27], 0
    v_mfma_f32_16x16x32_bf16 v[52:55], v[84:87], v[24:27], 0
    v_mfma_f32_16x16x32_bf16 v[56:59], v[88:91], v[24:27], 0
    v_mfma_f32_16x16x32_bf16 v[60:63], v[92:95], v[24:27], 0
    s_mov_b32 exec_lo, 0xf000f0
    s_mov_b32 exec_hi, 0xf000f0
    s_nop 1
    v_mov_b64 v[32:33], v[40:41]
    v_mov_b64 v[34:35], v[42:43]
    v_mov_b64 v[36:37], v[44:45]
    v_mov_b64 v[38:39], v[46:47]
    s_mov_b32 exec_lo, 0xf000f00
    s_mov_b32 exec_hi, 0xf000f00
    v_mov_b64 v[32:33], v[48:49]
    v_mov_b64 v[34:35], v[50:51]
    v_mov_b64 v[36:37], v[52:53]
    v_mov_b64 v[38:39], v[54:55]
    s_mov_b32 exec_lo, 0xf000f000
    s_mov_b32 exec_hi, 0xf000f000
    s_nop 1
    v_mov_b64 v[32:33], v[56:57]
    v_mov_b64 v[34:35], v[58:59]
    v_mov_b64 v[36:37], v[60:61]
    v_mov_b64 v[38:39], v[62:63]
    s_mov_b32 exec_lo, 0x33333333
    s_mov_b32 exec_hi, 0xcccccccc
    ds_write_b128 v3, v[32:35]
    ds_write_b128 v3, v[36:39] offset:128
    s_mov_b64 exec, -1
    s_waitcnt lgkmcnt(0)
    s_barrier
    ds_read_b32 v24, v4 offset:0
    ds_read_b32 v25, v4 offset:2176
    ds_read_b32 v26, v4 offset:4352
    ds_read_b32 v27, v4 offset:6528
    s_waitcnt lgkmcnt(2)
    v_add_f32 v24, v24, v25
    s_waitcnt lgkmcnt(0)
    v_add_f32 v26, v26, v27
    v_add_f32 v24, v24, v26
    s_nop 1
    v_add_f32_dpp v24, v24, v24 quad_perm:[1,0,3,2] row_mask:0xf bank_mask:0xf
    s_nop 1
    v_add_f32_dpp v24, v24, v24 quad_perm:[2,3,0,1] row_mask:0xf bank_mask:0xf
    v_and_or_b32 v24, v24, v9, s26
    v_subrev_u32 v25, 25856, v5
    v_lshlrev_b32 v25, 1, v25
    ds_write_b32 v25, v24 offset:26112
    s_waitcnt lgkmcnt(0)
    s_barrier
    s_cmp_lg_u32 s3, 0
    s_cbranch_scc1 L_skip_60
    v_lshlrev_b32 v28, 4, v0
    ds_read_b128 v[24:27], v28 offset:26112
    v_bfe_u32 v29, v0, 4, 1
    v_lshlrev_b32 v29, 14, v29
    v_and_b32 v30, 15, v0
    v_lshl_add_u32 v29, v30, 4, v29
    s_waitcnt lgkmcnt(0)
    s_mov_b32 exec_hi, 0
    buffer_store_dwordx4 v[24:27], v29, s[48:51], s12 offen sc1
    s_mov_b64 exec, -1
    s_nop 0
L_skip_60:
    v_bfe_u32 v29, v7, 4, 2
    v_lshlrev_b32 v29, 12, v29
    v_bfe_u32 v31, v7, 6, 3
    v_lshl_add_u32 v29, v31, 8, v29
    v_and_b32 v31, 15, v7
    v_lshl_add_u32 v29, v31, 4, v29
    s_mov_b32 s56, s24
    s_mov_b32 s57, s25
    s_mov_b32 s58, 0x800000
    s_mov_b32 s59, 0x20000
    s_lshl_b32 s5, s14, 17
    s_add_u32 s4, s5, 0
    buffer_load_dwordx4 v[192:195], v29, s[56:59], s4 offen nt
    s_add_u32 s4, s5, 16384
    buffer_load_dwordx4 v[200:203], v29, s[56:59], s4 offen nt
    s_add_u32 s4, s5, 32768
    buffer_load_dwordx4 v[208:211], v29, s[56:59], s4 offen nt
    s_add_u32 s4, s5, 49152
    buffer_load_dwordx4 v[216:219], v29, s[56:59], s4 offen nt
    s_add_u32 s4, s5, 2048
    buffer_load_dwordx4 v[224:227], v29, s[56:59], s4 offen nt
    s_add_u32 s4, s5, 18432
    buffer_load_dwordx4 v[232:235], v29, s[56:59], s4 offen nt
    s_add_u32 s4, s5, 34816
    buffer_load_dwordx4 v[240:243], v29, s[56:59], s4 offen nt
    s_add_u32 s4, s5, 51200
    buffer_load_dwordx4 v[248:251], v29, s[56:59], s4 offen nt
    s_add_u32 s4, s5, 65536
    buffer_load_dwordx4 v[196:199], v29, s[56:59], s4 offen nt
    s_add_u32 s4, s5, 81920
    buffer_load_dwordx4 v[204:207], v29, s[56:59], s4 offen nt
    s_add_u32 s4, s5, 98304
    buffer_load_dwordx4 v[212:215], v29, s[56:59], s4 offen nt
    s_add_u32 s4, s5, 114688
    buffer_load_dwordx4 v[220:223], v29, s[56:59], s4 offen nt
    s_add_u32 s4, s5, 67584
    buffer_load_dwordx4 v[228:231], v29, s[56:59], s4 offen nt
    s_add_u32 s4, s5, 83968
    buffer_load_dwordx4 v[236:239], v29, s[56:59], s4 offen nt
    s_add_u32 s4, s5, 100352
    buffer_load_dwordx4 v[244:247], v29, s[56:59], s4 offen nt
    s_add_u32 s4, s5, 116736
    buffer_load_dwordx4 v[252:255], v29, s[56:59], s4 offen nt
    s_mov_b32 s15, s68
    s_mov_b32 s6, s69
    s_lshl_b32 s12, s15, 15
    s_lshl_b32 s5, s6, 1
    s_add_u32 s12, s12, s5
    s_add_u32 s12, s12, 262144
    s_lshr_b32 s4, s3, 2
    s_sub_u32 s4, s15, s4
    s_lshl_b32 s4, s4, 9
    v_add_u32 v8, s4, v2
    v_mov_b32 v9, 0xffffff00
    s_waitcnt vmcnt(16)
    v_perm_b32 v24, v100, v96, s64
    v_perm_b32 v100, v100, v96, s65
    v_mov_b32 v96, v24
    v_perm_b32 v24, v109, v105, s64
    v_perm_b32 v109, v109, v105, s65
    v_mov_b32 v105, v24
    v_perm_b32 v24, v118, v114, s64
    v_perm_b32 v118, v118, v114, s65
    v_mov_b32 v114, v24
    v_perm_b32 v24, v127, v123, s64
    v_perm_b32 v127, v127, v123, s65
    v_mov_b32 v123, v24
    v_perm_b32 v24, v101, v97, s64
    v_perm_b32 v25, v101, v97, s65
    v_perm_b32 v97, v108, v104, s64
    v_perm_b32 v101, v108, v104, s65
    v_mov_b32 v104, v24
    v_mov_b32 v108, v25
    v_perm_b32 v24, v102, v98, s64
    v_perm_b32 v25, v102, v98, s65
    v_perm_b32 v98, v116, v112, s64
    v_perm_b32 v102, v116, v112, s65
    v_mov_b32 v112, v24
    v_mov_b32 v116, v25
    v_perm_b32 v24, v103, v99, s64
    v_perm_b32 v25, v103, v99, s65
    v_perm_b32 v99, v124, v120, s64
    v_perm_b32 v103, v124, v120, s65
    v_mov_b32 v120, v24
    v_mov_b32 v124, v25
    v_perm_b32 v24, v110, v106, s64
    v_perm_b32 v25, v110, v106, s65
    v_perm_b32 v106, v117, v113, s64
    v_perm_b32 v110, v117, v113, s65
    v_mov_b32 v113, v24
    v_mov_b32 v117, v25
    v_perm_b32 v24, v111, v107, s64
    v_perm_b32 v25, v111, v107, s65
    v_perm_b32 v107, v125, v121, s64
    v_perm_b32 v111, v125, v121, s65
    v_mov_b32 v121, v24
    v_mov_b32 v125, v25
    v_perm_b32 v24, v119, v115, s64
    v_perm_b32 v25, v119, v115, s65
    v_perm_b32 v115, v126, v122, s64
    v_perm_b32 v119, v126, v122, s65
    v_mov_b32 v122, v24
    v_mov_b32 v126, v25
    ds_read_b128 v[24:27], v8 offset:8448
    s_waitcnt lgkmcnt(0)
    v_mfma_f32_16x16x32_bf16 v[32:35], v[96:99], v[24:27], 0
    v_mfma_f32_16x16x32_bf16 v[36:39], v[100:103], v[24:27], 0
    v_mfma_f32_16x16x32_bf16 v[40:43], v[104:107], v[24:27], 0
    v_mfma_f32_16x16x32_bf16 v[44:47], v[108:111], v[24:27], 0
    v_mfma_f32_16x16x32_bf16 v[48:51], v[112:115], v[24:27], 0
    v_mfma_f32_16x16x32_bf16 v[52:55], v[116:119], v[24:27], 0
    v_mfma_f32_16x16x32_bf16 v[56:59], v[120:123], v[24:27], 0
    v_mfma_f32_16x16x32_bf16 v[60:63], v[124:127], v[24:27], 0
    s_mov_b32 exec_lo, 0xf000f0
    s_mov_b32 exec_hi, 0xf000f0
    s_nop 1
    v_mov_b64 v[32:33], v[40:41]
    v_mov_b64 v[34:35], v[42:43]
    v_mov_b64 v[36:37], v[44:45]
    v_mov_b64 v[38:39], v[46:47]
    s_mov_b32 exec_lo, 0xf000f00
    s_mov_b32 exec_hi, 0xf000f00
    v_mov_b64 v[32:33], v[48:49]
    v_mov_b64 v[34:35], v[50:51]
    v_mov_b64 v[36:37], v[52:53]
    v_mov_b64 v[38:39], v[54:55]
    s_mov_b32 exec_lo, 0xf000f000
    s_mov_b32 exec_hi, 0xf000f000
    s_nop 1
    v_mov_b64 v[32:33], v[56:57]
    v_mov_b64 v[34:35], v[58:59]
    v_mov_b64 v[36:37], v[60:61]
    v_mov_b64 v[38:39], v[62:63]
    s_mov_b32 exec_lo, 0x33333333
    s_mov_b32 exec_hi, 0xcccccccc
    ds_write_b128 v3, v[32:35]
    ds_write_b128 v3, v[36:39] offset:128
    s_mov_b64 exec, -1
    s_waitcnt lgkmcnt(0)
    s_barrier
    ds_read_b32 v24, v4 offset:0
    ds_read_b32 v25, v4 offset:2176
    ds_read_b32 v26, v4 offset:4352
    ds_read_b32 v27, v4 offset:6528
    s_waitcnt lgkmcnt(2)
    v_add_f32 v24, v24, v25
    s_waitcnt lgkmcnt(0)
    v_add_f32 v26, v26, v27
    v_add_f32 v24, v24, v26
    s_nop 1
    v_add_f32_dpp v24, v24, v24 quad_perm:[1,0,3,2] row_mask:0xf bank_mask:0xf
    s_nop 1
    v_add_f32_dpp v24, v24, v24 quad_perm:[2,3,0,1] row_mask:0xf bank_mask:0xf
    v_and_or_b32 v24, v24, v9, s26
    v_subrev_u32 v25, 25856, v5
    v_lshlrev_b32 v25, 1, v25
    ds_write_b32 v25, v24 offset:26112
    s_waitcnt lgkmcnt(0)
    s_barrier
    s_cmp_lg_u32 s3, 0
    s_cbranch_scc1 L_skip_61
    v_lshlrev_b32 v28, 4, v0
    ds_read_b128 v[24:27], v28 offset:26112
    v_bfe_u32 v29, v0, 4, 1
    v_lshlrev_b32 v29, 14, v29
    v_and_b32 v30, 15, v0
    v_lshl_add_u32 v29, v30, 4, v29
    s_waitcnt lgkmcnt(0)
    s_mov_b32 exec_hi, 0
    buffer_store_dwordx4 v[24:27], v29, s[48:51], s12 offen sc1
    s_mov_b64 exec, -1
    s_nop 0
L_skip_61:
    s_and_b32 s15, s14, 1
    v_bfe_u32 v9, v7, 3, 6
    v_lshlrev_b32 v9, 8, v9
    v_and_b32 v24, 7, v7
    v_lshl_add_u32 v9, v24, 4, v9
    s_waitcnt vmcnt(0)
    v_perm_b32 v24, v200, v192, s64
    v_perm_b32 v200, v200, v192, s65
    v_mov_b32 v192, v24
    v_perm_b32 v24, v217, v209, s64
    v_perm_b32 v217, v217, v209, s65
    v_mov_b32 v209, v24
    v_perm_b32 v24, v234, v226, s64
    v_perm_b32 v234, v234, v226, s65
    v_mov_b32 v226, v24
    v_perm_b32 v24, v251, v243, s64
    v_perm_b32 v251, v251, v243, s65
    v_mov_b32 v243, v24
    v_perm_b32 v24, v201, v193, s64
    v_perm_b32 v25, v201, v193, s65
    v_perm_b32 v193, v216, v208, s64
    v_perm_b32 v201, v216, v208, s65
    v_mov_b32 v208, v24
    v_mov_b32 v216, v25
    v_perm_b32 v24, v202, v194, s64
    v_perm_b32 v25, v202, v194, s65
    v_perm_b32 v194, v232, v224, s64
    v_perm_b32 v202, v232, v224, s65
    v_mov_b32 v224, v24
    v_mov_b32 v232, v25
    v_perm_b32 v24, v203, v195, s64
    v_perm_b32 v25, v203, v195, s65
    v_perm_b32 v195, v248, v240, s64
    v_perm_b32 v203, v248, v240, s65
    v_mov_b32 v240, v24
    v_mov_b32 v248, v25
    v_perm_b32 v24, v218, v210, s64
    v_perm_b32 v25, v218, v210, s65
    v_perm_b32 v210, v233, v225, s64
    v_perm_b32 v218, v233, v225, s65
    v_mov_b32 v225, v24
    v_mov_b32 v233, v25
    v_perm_b32 v24, v219, v211, s64
    v_perm_b32 v25, v219, v211, s65
    v_perm_b32 v211, v249, v241, s64
    v_perm_b32 v219, v249, v241, s65
    v_mov_b32 v241, v24
    v_mov_b32 v249, v25
    v_perm_b32 v24, v235, v227, s64
    v_perm_b32 v25, v235, v227, s65
    v_perm_b32 v227, v250, v242, s64
    v_perm_b32 v235, v250, v242, s65
    v_mov_b32 v242, v24
    v_mov_b32 v250, v25
    v_perm_b32 v24, v204, v196, s64
    v_perm_b32 v204, v204, v196, s65
    v_mov_b32 v196, v24
    v_perm_b32 v24, v221, v213, s64
    v_perm_b32 v221, v221, v213, s65
    v_mov_b32 v213, v24
    v_perm_b32 v24, v238, v230, s64
    v_perm_b32 v238, v238, v230, s65
    v_mov_b32 v230, v24
    v_perm_b32 v24, v255, v247, s64
    v_perm_b32 v255, v255, v247, s65
    v_mov_b32 v247, v24
    v_perm_b32 v24, v205, v197, s64
    v_perm_b32 v25, v205, v197, s65
    v_perm_b32 v197, v220, v212, s64
    v_perm_b32 v205, v220, v212, s65
    v_mov_b32 v212, v24
    v_mov_b32 v220, v25
    v_perm_b32 v24, v206, v198, s64
    v_perm_b32 v25, v206, v198, s65
    v_perm_b32 v198, v236, v228, s64
    v_perm_b32 v206, v236, v228, s65
    v_mov_b32 v228, v24
    v_mov_b32 v236, v25
    v_perm_b32 v24, v207, v199, s64
    v_perm_b32 v25, v207, v199, s65
    v_perm_b32 v199, v252, v244, s64
    v_perm_b32 v207, v252, v244, s65
    v_mov_b32 v244, v24
    v_mov_b32 v252, v25
    v_perm_b32 v24, v222, v214, s64
    v_perm_b32 v25, v222, v214, s65
    v_perm_b32 v214, v237, v229, s64
    v_perm_b32 v222, v237, v229, s65
    v_mov_b32 v229, v24
    v_mov_b32 v237, v25
    v_perm_b32 v24, v223, v215, s64
    v_perm_b32 v25, v223, v215, s65
    v_perm_b32 v215, v253, v245, s64
    v_perm_b32 v223, v253, v245, s65
    v_mov_b32 v245, v24
    v_mov_b32 v253, v25
    v_perm_b32 v24, v239, v231, s64
    v_perm_b32 v25, v239, v231, s65
    v_perm_b32 v231, v254, v246, s64
    v_perm_b32 v239, v254, v246, s65
    v_mov_b32 v246, v24
    v_mov_b32 v254, v25
    s_lshl_b32 s4, s14, 5
    v_and_b32 v24, 7, v0
    v_lshlrev_b32 v24, 2, v24
    v_add_u32 v24, s4, v24
    s_mov_b32 s60, s34
    s_mov_b32 s61, s35
    s_mov_b32 s62, 0x800
    s_mov_b32 s63, 0x20000
    buffer_load_dword v23, v24, s[60:63], 0 offen
    v_bfe_u32 v25, v0, 3, 1
    v_lshlrev_b32 v21, 1, v24
    v_lshl_add_u32 v21, v25, 14, v21
    v_lshl_add_u32 v11, v25, 11, v24
    s_mov_b32 s60, s16
    s_mov_b32 s61, s17
    s_mov_b32 s62, 0x1000
    s_mov_b32 s63, 0x20000
    buffer_load_dword v20, v11, s[60:63], 0 offen
    s_cmp_lg_u32 s3, 0
    s_cbranch_scc1 L_skip_62
    s_mov_b32 s4, 262144
    s_mov_b32 s5, 294912
    s_mov_b32 s6, 327680
    s_mov_b32 s47, 360448
    s_mov_b32 s67, 262144
L_poll_63:
    buffer_load_dwordx2 v[50:51], v21, s[48:51], s4 offen sc1
    buffer_load_dwordx2 v[52:53], v21, s[48:51], s5 offen sc1
    buffer_load_dwordx2 v[54:55], v21, s[48:51], s6 offen sc1
    buffer_load_dwordx2 v[56:57], v21, s[48:51], s47 offen sc1
    s_waitcnt vmcnt(0)
    v_xor_b32 v50, s26, v50
    v_xor_b32 v51, s26, v51
    v_xor_b32 v52, s26, v52
    v_xor_b32 v53, s26, v53
    v_xor_b32 v54, s26, v54
    v_xor_b32 v55, s26, v55
    v_xor_b32 v56, s26, v56
    v_xor_b32 v57, s26, v57
    v_or_b32 v28, v50, v51
    v_or3_b32 v28, v28, v52, v53
    v_or3_b32 v28, v28, v54, v55
    v_or3_b32 v28, v28, v56, v57
    v_and_b32 v28, 255, v28
    v_cmp_ne_u32 vcc, 0, v28
    s_cbranch_vccz L_ok_64
    s_sleep 16
    s_sub_u32 s67, s67, 1
    s_cbranch_scc0 L_poll_63
L_ok_64:
    v_pk_add_f32 v[50:51], v[50:51], v[54:55]
    v_pk_add_f32 v[52:53], v[52:53], v[56:57]
    v_pk_add_f32 v[50:51], v[50:51], v[52:53]
    v_cvt_pk_bf16_f32 v22, v50, v51
L_skip_62:
    s_mov_b32 s60, s40
    s_mov_b32 s61, s41
    s_mov_b32 s62, 0x1000
    s_mov_b32 s63, 0x20000
    v_bfe_u32 v10, v7, 6, 3
    v_lshlrev_b32 v10, 7, v10
    v_bfe_u32 v24, v7, 5, 1
    v_lshl_add_u32 v10, v24, 6, v10
    v_and_b32 v24, 7, v7
    v_lshl_add_u32 v10, v24, 3, v10
    v_bfe_u32 v24, v7, 4, 1
    v_lshl_add_u32 v10, v24, 2, v10
    v_add_u32 v10, 26112, v10
    v_bfe_u32 v8, v7, 6, 3
    v_mul_u32_u24 v8, 66560, v8
    v_bfe_u32 v24, v7, 2, 2
    v_mul_u32_u24 v24, 16640, v24
    v_add_u32 v8, v8, v24
    v_bfe_u32 v24, v7, 1, 1
    v_lshl_add_u32 v8, v24, 7, v8
    v_and_b32 v24, 1, v7
    v_lshl_add_u32 v8, v24, 6, v8
    v_bfe_u32 v24, v7, 4, 2
    v_lshl_add_u32 v8, v24, 4, v8
    v_bfe_u32 v6, v7, 1, 1
    v_lshlrev_b32 v6, 7, v6
    v_bfe_u32 v24, v7, 4, 2
    v_lshl_add_u32 v6, v24, 5, v6
    v_and_b32 v24, 1, v7
    v_lshl_add_u32 v6, v24, 4, v6
    v_add_u32 v6, 25856, v6
    s_lshl_b32 s12, s7, 1
    s_add_u32 s12, s12, 2097152
    v_bfe_u32 v17, v7, 8, 1
    v_lshlrev_b32 v17, 13, v17
    v_bfe_u32 v27, v7, 3, 3
    v_lshl_add_u32 v17, v27, 8, v17
    v_bfe_u32 v27, v7, 6, 2
    v_lshl_add_u32 v17, v27, 6, v17
    v_and_b32 v27, 7, v7
    v_lshl_add_u32 v17, v27, 3, v17
    v_bfe_u32 v16, v7, 6, 3
    v_lshlrev_b32 v16, 5, v16
    v_and_b32 v27, 1, v7
    v_lshl_add_u32 v16, v27, 4, v16
    v_bfe_u32 v27, v7, 1, 2
    v_lshl_add_u32 v16, v27, 2, v16
    v_bfe_u32 v27, v7, 5, 1
    v_lshl_add_u32 v16, v27, 1, v16
    v_add_u32 v16, 25856, v16
    v_bfe_u32 v29, v7, 8, 1
    v_lshlrev_b32 v29, 7, v29
    v_bfe_u32 v27, v7, 3, 3
    v_lshl_add_u32 v29, v27, 2, v29
    s_add_u32 s13, s8, 4096
    v_bfe_u32 v26, v0, 5, 1
    v_lshlrev_b32 v26, 13, v26
    v_and_b32 v27, 31, v0
    v_lshl_add_u32 v26, v27, 3, v26
    s_lshr_b32 s4, s14, 1
    s_lshl_b32 s4, s4, 8
    s_add_u32 s4, s4, 65536
    s_getpc_b64 s[98:99]
L_pc_66:
    s_add_u32 s98, s98, L_proj_tail-L_pc_66
    s_addc_u32 s99, s99, 0
    s_and_b32 s98, s98, 0xffffff80
    s_lshl_b32 s97, s3, 10
    v_lshl_add_u32 v30, v0, 4, s97
    global_load_dwordx4 v[32:35], v30, s[98:99]
    v_and_b32 v19, 1, v0
    v_mul_u32_u24 v19, 0xaaaa, v19
    v_add_u32 v19, 0x4444, v19
    v_mov_b64 v[64:65], 0
    v_mov_b64 v[66:67], 0
    v_mov_b64 v[68:69], 0
    v_mov_b64 v[70:71], 0
    v_mov_b64 v[72:73], 0
    v_mov_b64 v[74:75], 0
    v_mov_b64 v[76:77], 0
    v_mov_b64 v[78:79], 0
    v_mov_b64 v[80:81], 0
    v_mov_b64 v[82:83], 0
    v_mov_b64 v[84:85], 0
    v_mov_b64 v[86:87], 0
    v_mov_b64 v[88:89], 0
    v_mov_b64 v[90:91], 0
    v_mov_b64 v[92:93], 0
    v_mov_b64 v[94:95], 0
    s_waitcnt vmcnt(0)
L_proj_tail:
    s_cmp_lg_u32 s3, 0
    s_cbranch_scc1 L_skip_68
    s_mov_b32 s67, 262144
L_p1_67:
    buffer_load_dwordx2 v[40:41], v17, s[48:51], s8 offen offset:0 sc1
    s_waitcnt vmcnt(0)
    v_xor_b32 v40, s26, v40
    v_xor_b32 v41, s26, v41
    v_or_b32 v32, v40, v41
    v_and_b32 v32, 255, v32
    v_cmp_ne_u32 vcc, 0, v32
    s_bcnt1_i32_b64 s5, vcc
    s_cmp_le_u32 s5, 56
    s_cbranch_scc1 L_skip_68
    s_sleep 8
    s_sub_u32 s67, s67, 1
    s_cbranch_scc0 L_p1_67
L_skip_68:
    s_barrier
    v_mov_b32 v24, 0xff800000
    v_mov_b32 v25, 0
    s_mov_b32 exec_lo, 0xffffff
    s_mov_b32 exec_hi, 0xffffff
    s_mov_b32 s67, 262144
L_poll_69:
    buffer_load_dwordx2 v[24:25], v26, s[48:51], s4 offen sc1
    s_waitcnt vmcnt(0)
    v_xor_b32 v24, s1, v24
    v_xor_b32 v25, s26, v25
    v_and_b32 v28, 255, v25
    v_or_b32 v28, v28, v24
    v_cmp_ne_u16 vcc, 0, v28
    s_cbranch_vccz L_ok_70
    s_sleep 2
    s_sub_u32 s67, s67, 1
    s_cbranch_scc0 L_poll_69
L_ok_70:
    s_mov_b64 exec, -1
    v_and_b32 v24, s66, v24
    v_mov_b32 v26, v24
    s_nop 1
    v_max_f32_dpp v26, v26, v26 row_ror:8 row_mask:0xf bank_mask:0xf
    s_nop 1
    v_max_f32_dpp v26, v26, v26 row_ror:4 row_mask:0xf bank_mask:0xf
    s_nop 1
    v_max_f32_dpp v26, v26, v26 row_ror:2 row_mask:0xf bank_mask:0xf
    s_nop 1
    v_max_f32_dpp v26, v26, v26 row_ror:1 row_mask:0xf bank_mask:0xf
    v_mov_b32 v27, v26
    s_nop 1
    v_permlane16_swap_b32 v26, v27
    v_max_f32 v26, v26, v27
    v_sub_f32 v24, v24, v26
    v_mul_f32 v24, 0x3fb8aa3b, v24
    v_exp_f32 v24, v24
    s_nop 0
    v_mul_f32 v25, v25, v24
    s_nop 1
    v_add_f32_dpp v25, v25, v25 row_ror:8 row_mask:0xf bank_mask:0xf
    s_nop 1
    v_add_f32_dpp v25, v25, v25 row_ror:4 row_mask:0xf bank_mask:0xf
    s_nop 1
    v_add_f32_dpp v25, v25, v25 row_ror:2 row_mask:0xf bank_mask:0xf
    s_nop 1
    v_add_f32_dpp v25, v25, v25 row_ror:1 row_mask:0xf bank_mask:0xf
    v_mov_b32 v27, v25
    s_nop 1
    v_permlane16_swap_b32 v25, v27
    v_add_f32 v25, v25, v27
    v_rcp_f32 v25, v25
    s_nop 0
    v_mul_f32 v24, v24, v25
    ds_bpermute_b32 v12, v29, v24 offset:0
    ds_bpermute_b32 v13, v29, v24 offset:32
    ds_bpermute_b32 v14, v29, v24 offset:64
    ds_bpermute_b32 v15, v29, v24 offset:96
    s_waitcnt lgkmcnt(0)
    s_cmp_lg_u32 s3, 0
    s_cbranch_scc1 L_skip_73
    s_mov_b32 s67, 262144
L_p1_72:
    buffer_load_dwordx2 v[40:41], v17, s[48:51], s8 offen offset:0 sc1
    s_waitcnt vmcnt(0)
    v_xor_b32 v40, s26, v40
    v_xor_b32 v41, s26, v41
    v_or_b32 v32, v40, v41
    v_and_b32 v32, 255, v32
    v_cmp_ne_u32 vcc, 0, v32
    s_bcnt1_i32_b64 s5, vcc
    s_cmp_le_u32 s5, 16
    s_cbranch_scc1 L_skip_73
    s_sleep 2
    s_sub_u32 s67, s67, 1
    s_cbranch_scc0 L_p1_72
L_skip_73:
    s_barrier
    s_mov_b32 s67, 262144
L_poll_74:
    buffer_load_dwordx2 v[24:25], v17, s[48:51], s8 offen offset:0 sc1
    buffer_load_dwordx2 v[26:27], v17, s[48:51], s8 offen offset:2048 sc1
    buffer_load_dwordx2 v[28:29], v17, s[48:51], s13 offen offset:0 sc1
    s_waitcnt vmcnt(0)
    v_xor_b32 v24, s26, v24
    v_xor_b32 v25, s26, v25
    v_xor_b32 v26, s26, v26
    v_xor_b32 v27, s26, v27
    v_xor_b32 v28, s26, v28
    v_xor_b32 v29, s26, v29
    v_or_b32 v32, v24, v25
    v_or3_b32 v32, v32, v26, v27
    v_or3_b32 v32, v32, v28, v29
    v_and_b32 v32, 255, v32
    v_cmp_ne_u32 vcc, 0, v32
    s_cbranch_vccz L_ok_75
    s_sub_u32 s67, s67, 1
    s_cbranch_scc0 L_poll_74
L_ok_75:
    v_mul_f32 v24, v12, v24
    v_mul_f32 v25, v12, v25
    v_fmac_f32 v24, v13, v26
    v_fmac_f32 v25, v13, v27
    v_fmac_f32 v24, v14, v28
    v_fmac_f32 v25, v14, v29
    s_nop 1
    v_permlane32_swap_b32 v24, v25
    v_add_f32 v24, v24, v25
    v_mov_b32 v25, v24
    s_nop 1
    v_permlane16_swap_b32 v24, v25
    v_add_f32 v24, v24, v25
    s_nop 1
    v_add_f32_dpp v24, v24, v24 row_ror:8 row_mask:0xf bank_mask:0xf
    v_cvt_pk_bf16_f32 v24, v24, v24
    ds_write_b16 v16, v24
    s_waitcnt lgkmcnt(0)
    s_barrier
    ds_read_b128 v[24:27], v6
    s_waitcnt lgkmcnt(0)
    v_smfmac_f32_16x16x64_bf16 v[64:67], v[24:27], v[192:199], v19
    v_mov_b32 v6, 0xffffff00
    s_nop 0
    v_smfmac_f32_16x16x64_bf16 v[68:71], v[24:27], v[200:207], v19
    s_nop 1
    v_smfmac_f32_16x16x64_bf16 v[72:75], v[24:27], v[208:215], v19
    s_nop 1
    v_smfmac_f32_16x16x64_bf16 v[76:79], v[24:27], v[216:223], v19
    v_add_f32_dpp v28, v64, v65 quad_perm:[0,1,2,3] row_mask:0x1 bank_mask:0xf
    v_add_f32_dpp v30, v66, v67 quad_perm:[0,1,2,3] row_mask:0x1 bank_mask:0xf
    v_smfmac_f32_16x16x64_bf16 v[80:83], v[24:27], v[224:231], v19
    v_add_f32_dpp v29, v68, v69 quad_perm:[0,1,2,3] row_mask:0x1 bank_mask:0xf
    v_add_f32_dpp v31, v70, v71 quad_perm:[0,1,2,3] row_mask:0x1 bank_mask:0xf
    v_smfmac_f32_16x16x64_bf16 v[84:87], v[24:27], v[232:239], v19
    v_add_f32_dpp v28, v72, v73 quad_perm:[0,1,2,3] row_mask:0x2 bank_mask:0xf
    v_add_f32_dpp v30, v74, v75 quad_perm:[0,1,2,3] row_mask:0x2 bank_mask:0xf
    v_smfmac_f32_16x16x64_bf16 v[88:91], v[24:27], v[240:247], v19
    v_add_f32_dpp v29, v76, v77 quad_perm:[0,1,2,3] row_mask:0x2 bank_mask:0xf
    v_add_f32_dpp v31, v78, v79 quad_perm:[0,1,2,3] row_mask:0x2 bank_mask:0xf
    v_smfmac_f32_16x16x64_bf16 v[92:95], v[24:27], v[248:255], v19
    v_add_f32_dpp v28, v80, v81 quad_perm:[0,1,2,3] row_mask:0x4 bank_mask:0xf
    v_add_f32_dpp v30, v82, v83 quad_perm:[0,1,2,3] row_mask:0x4 bank_mask:0xf
    v_add_f32_dpp v29, v84, v85 quad_perm:[0,1,2,3] row_mask:0x4 bank_mask:0xf
    v_add_f32_dpp v31, v86, v87 quad_perm:[0,1,2,3] row_mask:0x4 bank_mask:0xf
    s_nop 0
    v_add_f32_dpp v28, v88, v89 quad_perm:[0,1,2,3] row_mask:0x8 bank_mask:0xf
    v_add_f32_dpp v30, v90, v91 quad_perm:[0,1,2,3] row_mask:0x8 bank_mask:0xf
    s_nop 0
    v_add_f32_dpp v29, v92, v93 quad_perm:[0,1,2,3] row_mask:0x8 bank_mask:0xf
    v_add_f32_dpp v31, v94, v95 quad_perm:[0,1,2,3] row_mask:0x8 bank_mask:0xf
    v_and_or_b32 v28, v28, v6, s26
    v_and_or_b32 v29, v29, v6, s26
    v_and_or_b32 v30, v30, v6, s26
    v_and_or_b32 v31, v31, v6, s26
    buffer_store_dwordx4 v[28:31], v8, s[48:51], s12 offen sc1
    s_nop 1
    s_waitcnt vmcnt(0)
    s_mov_b32 s67, 262144
L_poll_79:
    buffer_load_dwordx4 v[24:27], v9, s[48:51], s9 offen sc1
    s_waitcnt vmcnt(0)
    v_xor_b32 v24, s26, v24
    v_xor_b32 v25, s26, v25
    v_xor_b32 v26, s26, v26
    v_xor_b32 v27, s26, v27
    v_or_b32 v28, v24, v25
    v_or3_b32 v28, v28, v26, v27
    v_and_b32 v28, 255, v28
    v_cmp_ne_u32 vcc, 0, v28
    s_cbranch_vccz L_ok_80
    s_sub_u32 s67, s67, 1
    s_cbranch_scc0 L_poll_79
L_ok_80:
L_red1_78:
    v_permlane32_swap_b32 v24, v26
    v_permlane32_swap_b32 v25, v27
    v_add_f32 v24, v24, v26
    v_add_f32 v25, v25, v27
    s_nop 1
    v_permlane16_swap_b32 v24, v25
    v_add_f32 v24, v24, v25
    s_nop 1
    v_add_f32_dpp v24, v24, v24 row_ror:8 row_mask:0xf bank_mask:0xf
    ds_write_b32 v10, v24
    s_waitcnt lgkmcnt(0)
    s_barrier
    s_cmp_lg_u32 s3, 0
    s_cbranch_scc1 L_skip_82
    v_and_b32 v26, 15, v0
    v_lshlrev_b32 v26, 3, v26
    ds_read_b64 v[32:33], v26 offset:26112
    ds_read_b64 v[34:35], v26 offset:26240
    ds_read_b64 v[36:37], v26 offset:26368
    ds_read_b64 v[38:39], v26 offset:26496
    ds_read_b64 v[40:41], v26 offset:26624
    ds_read_b64 v[42:43], v26 offset:26752
    ds_read_b64 v[44:45], v26 offset:26880
    ds_read_b64 v[46:47], v26 offset:27008
    v_lshlrev_b32 v50, 16, v22
    v_and_b32 v51, s66, v22
    v_lshlrev_b32 v30, 16, v20
    v_and_b32 v31, s66, v20
    v_lshrrev_b32 v27, 4, v0
    v_lshl_add_u32 v27, v27, 13, v26
    s_add_u32 s4, s11, 32768
    v_mov_b32 v48, s66
    s_waitcnt lgkmcnt(4)
    v_pk_add_f32 v[32:33], v[32:33], v[36:37]
    v_pk_add_f32 v[34:35], v[34:35], v[38:39]
    s_waitcnt lgkmcnt(0)
    v_pk_add_f32 v[40:41], v[40:41], v[44:45]
    v_pk_add_f32 v[42:43], v[42:43], v[46:47]
    v_pk_add_f32 v[32:33], v[32:33], v[40:41]
    v_pk_add_f32 v[34:35], v[34:35], v[42:43]
    v_pk_add_f32 v[24:25], v[32:33], v[34:35]
    v_cvt_pk_bf16_f32 v24, 0, v24
    v_cvt_pk_bf16_f32 v25, 0, v25
    v_pk_mul_f32 v[24:25], v[24:25], v[50:51]
    v_cvt_pk_bf16_f32 v24, 0, v24
    v_cvt_pk_bf16_f32 v25, 0, v25
    v_pk_add_f32 v[24:25], v[24:25], v[30:31]
    v_cvt_pk_bf16_f32 v20, v24, v25
    v_lshl_or_b32 v24, v20, 16, s1
    v_and_or_b32 v25, v20, v48, s1
    buffer_store_dwordx2 v[24:25], v27, s[48:51], s11 offen sc1
    buffer_store_dwordx2 v[24:25], v27, s[48:51], s4 offen sc1
    s_cmp_lg_u32 s2, 0
    s_cbranch_scc1 L_skip_82
    v_mov_b32 v26, s27
    s_mov_b64 exec, 1
    buffer_store_dword v26, off, s[48:51], 0 sc1
    s_mov_b64 exec, -1
L_skip_82:
    s_barrier
    s_mov_b32 s4, 274432
    s_mov_b32 s5, 307200
    v_mov_b32 v24, 0
    s_cmp_ge_u32 s3, 7
    s_cbranch_scc1 L_nored_83
    s_cmp_eq_u32 s3, 0
    s_cbranch_scc1 L_red0_84
    s_mov_b32 s67, 262144
L_poll_86:
    buffer_load_dwordx4 v[24:27], v9, s[48:51], s10 offen sc1
    s_waitcnt vmcnt(0)
    v_xor_b32 v24, s26, v24
    v_xor_b32 v25, s26, v25
    v_xor_b32 v26, s26, v26
    v_xor_b32 v27, s26, v27
    v_or_b32 v28, v24, v25
    v_or3_b32 v28, v28, v26, v27
    v_and_b32 v28, 255, v28
    v_cmp_ne_u32 vcc, 0, v28
    s_cbranch_vccz L_ok_87
    s_sub_u32 s67, s67, 1
    s_cbranch_scc0 L_poll_86
L_ok_87:
    s_branch L_red1_85
L_red0_84:
    s_mov_b32 s67, 262144
L_poll_89:
    buffer_load_dwordx4 v[24:27], v9, s[48:51], s10 offen sc1
    buffer_load_dwordx2 v[50:51], v21, s[48:51], s4 offen sc1
    buffer_load_dwordx2 v[52:53], v21, s[48:51], s5 offen sc1
    s_waitcnt vmcnt(0)
    v_xor_b32 v24, s26, v24
    v_xor_b32 v25, s26, v25
    v_xor_b32 v26, s26, v26
    v_xor_b32 v27, s26, v27
    v_xor_b32 v50, s26, v50
    v_xor_b32 v51, s26, v51
    v_xor_b32 v52, s26, v52
    v_xor_b32 v53, s26, v53
    v_or_b32 v28, v24, v25
    v_or3_b32 v28, v28, v26, v27
    v_or3_b32 v28, v28, v50, v51
    v_or3_b32 v28, v28, v52, v53
    v_and_b32 v28, 255, v28
    v_cmp_ne_u32 vcc, 0, v28
    s_cbranch_vccz L_ok_90
    s_sub_u32 s67, s67, 1
    s_cbranch_scc0 L_poll_89
L_ok_90:
L_red1_85:
    v_permlane32_swap_b32 v24, v26
    v_permlane32_swap_b32 v25, v27
    v_add_f32 v24, v24, v26
    v_add_f32 v25, v25, v27
    s_nop 1
    v_permlane16_swap_b32 v24, v25
    v_add_f32 v24, v24, v25
    s_nop 1
    v_add_f32_dpp v24, v24, v24 row_ror:8 row_mask:0xf bank_mask:0xf
L_nored_83:
    ds_write_b32 v10, v24
    s_waitcnt lgkmcnt(0)
    s_barrier
    s_cmp_lg_u32 s3, 0
    s_cbranch_scc1 L_skip_92
    v_and_b32 v26, 15, v0
    v_lshlrev_b32 v26, 3, v26
    ds_read_b64 v[32:33], v26 offset:26112
    ds_read_b64 v[34:35], v26 offset:26240
    ds_read_b64 v[36:37], v26 offset:26368
    ds_read_b64 v[38:39], v26 offset:26496
    ds_read_b64 v[40:41], v26 offset:26624
    ds_read_b64 v[42:43], v26 offset:26752
    ds_read_b64 v[44:45], v26 offset:26880
    ds_read_b64 v[46:47], v26 offset:27008
    v_pk_add_f32 v[50:51], v[50:51], v[52:53]
    v_cvt_pk_bf16_f32 v50, 0, v50
    v_cvt_pk_bf16_f32 v51, 0, v51
    v_lshlrev_b32 v26, 16, v23
    v_and_b32 v27, s66, v23
    v_lshlrev_b32 v30, 16, v20
    v_and_b32 v31, s66, v20
    s_waitcnt lgkmcnt(4)
    v_pk_add_f32 v[32:33], v[32:33], v[36:37]
    v_pk_add_f32 v[34:35], v[34:35], v[38:39]
    s_waitcnt lgkmcnt(0)
    v_pk_add_f32 v[40:41], v[40:41], v[44:45]
    v_pk_add_f32 v[42:43], v[42:43], v[46:47]
    v_pk_add_f32 v[32:33], v[32:33], v[40:41]
    v_pk_add_f32 v[34:35], v[34:35], v[42:43]
    v_pk_add_f32 v[24:25], v[32:33], v[34:35]
    v_cvt_pk_bf16_f32 v24, 0, v24
    v_cvt_pk_bf16_f32 v25, 0, v25
    v_pk_add_f32 v[24:25], v[24:25], v[26:27]
    v_cvt_pk_bf16_f32 v24, 0, v24
    v_cvt_pk_bf16_f32 v25, 0, v25
    v_pk_mul_f32 v[24:25], v[24:25], v[50:51]
    v_cvt_pk_bf16_f32 v24, 0, v24
    v_cvt_pk_bf16_f32 v25, 0, v25
    v_pk_add_f32 v[24:25], v[24:25], v[30:31]
    v_cvt_pk_bf16_f32 v24, v24, v25
    s_mov_b64 exec, 0xffff
    buffer_store_dword v24, v11, s[60:63], 0 offen
L_skip_92:
L_gend:
    s_endpgm
L_exit:
    s_endpgm
    .fill 2048, 4, 0xbf800000
.section .rodata,"a"
.p2align 6
.amdhsa_kernel adaLN_cond__gqa_block_cached__mixer_channel_mlp__decode_kernel
  .amdhsa_next_free_vgpr 256
  .amdhsa_next_free_sgpr 102
  .amdhsa_accum_offset 256
  .amdhsa_group_segment_fixed_size 0
  .amdhsa_kernarg_size 120
  .amdhsa_user_sgpr_count 2
  .amdhsa_user_sgpr_kernarg_segment_ptr 1
  .amdhsa_system_sgpr_workgroup_id_x 1
.end_amdhsa_kernel
```
